```python
import torch

def _softmax(x, axis=-1):
    return torch.softmax(x, dim=axis)
def _gelu(x):
    return torch.nn.functional.gelu(x, approximate="tanh")
def _silu(x):
    return torch.nn.functional.silu(x)
def _sigmoid(x):
    return torch.sigmoid(x)
def _layernorm(x, axis=-1, eps=1e-5):
    m = x.mean(dim=axis, keepdim=True)
    v = x.var(dim=axis, keepdim=True, unbiased=False)
    return (x - m) / torch.sqrt(v + eps)
def _scatter_add(tgt, idx, src, axis=0):
    return tgt.clone().index_add_(axis, idx, src)
def _segment_sum(src, seg, n):
    out = torch.zeros((n,) + src.shape[1:], dtype=src.dtype)
    return out.index_add_(0, seg, src)
def _pad(x, pw):
    flat = tuple(v for pair in reversed(pw) for v in pair)
    return torch.nn.functional.pad(x, flat)

kernel_name = 'sequential_preLN__compressed_kv_cla__glu_gated_glu__decode'

def setup_inputs():

    _w = (lambda a: (lambda t: t.to(torch.bfloat16) if t.is_floating_point() else t)(torch.as_tensor(a)))
    def _A_setup():
        B, H, Sq, Sk, D, M = 1, 32, 1, 4096, 192, 640
        Dc = 4 * D
        return {
            "x": _w((lambda *s: torch.randn(*s, dtype=torch.bfloat16) * 0.05)(B, Sq, M)),
            "c_kv": _w((lambda *s: torch.randn(*s, dtype=torch.bfloat16) * 0.4)(B, Sk, Dc)),
            "w_q": _w((lambda *s: torch.randn(*s, dtype=torch.bfloat16) * 3.2)(M, H, D) * (M ** -0.5)),
            "w_uk": _w((lambda *s: torch.randn(*s, dtype=torch.bfloat16) * 3.2)(Dc, H, D) * (Dc ** -0.5)),
            "w_uv": _w((lambda *s: torch.randn(*s, dtype=torch.bfloat16) * 0.4)(Dc, H, D) * (Dc ** -0.5)),
            "w_o": _w((lambda *s: torch.randn(*s, dtype=torch.bfloat16) * 0.4)(H, D, M) * ((H * D) ** -0.5)),
        }
    _A_in = _A_setup()

    def _B_setup():
        B, S, D, F = 1, 1, 640, 1536
        return {
            "x": _w((lambda *s: torch.randn(*s, dtype=torch.bfloat16) * 0.05)(B, S, D)),
            "w_gate": _w((lambda *s: torch.randn(*s, dtype=torch.bfloat16) * 0.05)(D, F)),
            "w_up": _w((lambda *s: torch.randn(*s, dtype=torch.bfloat16) * 0.05)(D, F)),
            "w_down": _w((lambda *s: torch.randn(*s, dtype=torch.bfloat16) * 0.05)(F, D)),
        }
    _B_in = _B_setup()

    return {
        "A_x": _A_in["x"],
        "A_c_kv": _A_in["c_kv"],
        "A_w_q": _A_in["w_q"],
        "A_w_uk": _A_in["w_uk"],
        "A_w_uv": _A_in["w_uv"],
        "A_w_o": _A_in["w_o"],
        "B_x": _B_in["x"],
        "B_w_gate": _B_in["w_gate"],
        "B_w_up": _B_in["w_up"],
        "B_w_down": _B_in["w_down"],
    }

def reference(A_x, A_c_kv, A_w_q, A_w_uk, A_w_uv, A_w_o, B_x, B_w_gate, B_w_up, B_w_down):
    def _A_ref(x, c_kv, w_q, w_uk, w_uv, w_o):
        B, Sq, M = x.shape[0], x.shape[1], x.shape[2]
        Sk = c_kv.shape[1]
        H, D = w_q.shape[1], w_q.shape[2]
        q = torch.einsum("bqm,mhd->bhqd", x, w_q)
        k = torch.einsum("bkc,chd->bhkd", c_kv, w_uk)
        v = torch.einsum("bkc,chd->bhkd", c_kv, w_uv)
        scores = torch.einsum("bhqd,bhkd->bhqk", q, k) * (D ** -0.5)
        off = Sk - Sq
        qi = torch.arange(Sq)[:, None]
        kj = torch.arange(Sk)[None, :]
        cmask = kj <= (qi + off)
        scores = torch.where(cmask[None, None], scores, -1e9)
        p = _softmax(scores, axis=-1)
        ctx = torch.einsum("bhqk,bhkd->bhqd", p, v)
        return torch.einsum("bhqd,hdm->bqm", ctx, w_o)

    def _B_ref(x, w_gate, w_up, w_down):
        g = torch.einsum("bsd,df->bsf", x, w_gate)
        u = torch.einsum("bsd,df->bsf", x, w_up)
        h = _sigmoid(g) * u
        return torch.einsum("bsf,fd->bsd", h, w_down)

    x = A_x
    h = x + _A_ref(_layernorm(x, axis=-1), A_c_kv, A_w_q, A_w_uk, A_w_uv, A_w_o)
    h2 = h + _B_ref(_layernorm(h, axis=-1), B_w_gate, B_w_up, B_w_down)
    return h2
```

```asm
; @launch grid=(256,1,1) block=(1024,1,1) lds=163840
.amdgcn_target "amdgcn-amd-amdhsa--gfx950"
.text
.globl sequential_preLN__compressed_kv_cla__glu_gated_glu__decode_kernel
.p2align 8
.type sequential_preLN__compressed_kv_cla__glu_gated_glu__decode_kernel,@function
sequential_preLN__compressed_kv_cla__glu_gated_glu__decode_kernel:
    s_cmp_ge_u32 s2, 256
    s_cbranch_scc1 L_END
    s_load_dwordx16 s[16:31], s[0:1], 0
    s_load_dwordx8 s[32:39], s[0:1], 64
    s_load_dwordx2 s[40:41], s[0:1], 96
    v_lshrrev_b32 v5, 6, v0
    v_and_b32 v1, 63, v0
    v_readfirstlane_b32 s3, v5
    v_lshrrev_b32 v2, 4, v1
    s_cmp_lg_u32 s3, 15
    s_cbranch_scc1 CT_1
    s_getpc_b64 s[10:11]
PC_2:
    s_sub_u32 s10, s10, PC_2-sequential_preLN__compressed_kv_cla__glu_gated_glu__decode_kernel
    s_subb_u32 s11, s11, 0
    s_lshr_b32 s9, s2, 3
    s_and_b32 s9, s9, 15
    s_lshl_b32 s9, s9, 10
    v_lshl_add_u32 v120, v1, 4, s9
    s_mov_b32 s9, L_END-sequential_preLN__compressed_kv_cla__glu_gated_glu__decode_kernel-16
    v_min_u32 v120, s9, v120
    global_load_dwordx4 v[120:123], v120, s[10:11]
CT_1:
    v_and_b32 v3, 15, v1
    s_and_b32 s4, s2, 7
    s_lshr_b32 s5, s2, 3
    s_mul_i32 s64, s3, 11
    s_lshr_b32 s64, s64, 5
    s_mul_i32 s65, s64, 3
    s_sub_u32 s65, s3, s65
    s_cmp_ge_u32 s5, 16
    s_cbranch_scc1 L_Y
L_X:
    s_lshr_b32 s9, s5, 2
    s_lshl_b32 s7, s4, 2
    s_add_u32 s7, s7, s9
    s_and_b32 s8, s5, 3
    v_lshrrev_b32 v17, 3, v1
    s_lshl_b32 s9, s65, 3
    v_add_u32 v17, s9, v17
    v_mul_u32_u24 v18, 43, v17
    v_lshrrev_b32 v18, 9, v18
    v_mul_u32_u24 v15, 12, v18
    v_sub_u32 v17, v17, v15
    v_lshlrev_b32 v18, 2, v18
    v_bfe_u32 v15, v1, 1, 2
    v_add_u32 v18, v18, v15
    s_mov_b32 s9, 12288
    v_mul_lo_u32 v18, v18, s9
    v_lshlrev_b32 v17, 5, v17
    v_and_b32 v15, 1, v1
    v_lshlrev_b32 v15, 4, v15
    v_add3_u32 v15, v15, v17, v18
    v_cmp_lt_u32 vcc, 23, v1
    v_subrev_u32 v6, 24, v1
    s_nop 0
    v_cndmask_b32 v14, v1, v6, vcc
    v_lshlrev_b32 v14, 4, v14
    v_mov_b32 v6, 12288
    v_cndmask_b32 v6, 0, v6, vcc
    v_add_u32 v14, v14, v6
    v_lshlrev_b32 v5, 2, v1
    v_lshlrev_b32 v11, 4, v1
    s_mul_i32 s10, s8, 160
    s_lshl_b32 s11, s64, 3
    s_add_u32 s10, s10, s11
    s_mul_i32 s11, s10, 12288
    s_mul_i32 s67, s7, 384
    s_add_u32 s11, s11, s67
    s_sub_u32 s9, s3, 12
    s_mul_i32 s66, s8, 192
    s_lshl_b32 s10, s9, 1
    s_add_u32 s66, s66, s10
    s_mul_i32 s66, s66, 12288
    s_add_u32 s66, s66, s67
    s_mul_i32 s68, s9, 800
    s_add_u32 s68, s68, 61440
    s_lshl_b32 s10, s3, 10
    s_waitcnt lgkmcnt(0)
    s_load_dword s6, s[40:41], 0
    s_mov_b32 s44, s40
    s_mov_b32 s45, s41
    s_mov_b32 s46, 7340032
    s_mov_b32 s47, 0x00020000
    s_mov_b32 s48, s20
    s_mov_b32 s49, s21
    s_mov_b32 s50, 7864320
    s_mov_b32 s51, 0x00020000
    s_mov_b32 s52, s22
    s_mov_b32 s53, s23
    s_mov_b32 s54, 9437184
    s_mov_b32 s55, 0x00020000
    s_mov_b32 s56, s16
    s_mov_b32 s57, s17
    s_mov_b32 s58, 1280
    s_mov_b32 s59, 0x00020000
    s_cmp_lg_u32 s3, 15
    s_cbranch_scc1 XL_3
    buffer_load_dword v16, v5, s[56:59], 0 offen offset:0
    buffer_load_dword v17, v5, s[56:59], 0 offen offset:256
    buffer_load_dword v18, v5, s[56:59], 0 offen offset:512
    buffer_load_dword v19, v5, s[56:59], 0 offen offset:768
    buffer_load_dword v20, v5, s[56:59], 0 offen offset:1024
    s_barrier
    s_branch X_LN
XL_3:
    s_cmp_ge_u32 s3, 12
    s_cbranch_scc1 X_UKD
    s_mov_b32 s12, 5
DMA_4:
    s_mov_b32 m0, s10
    s_add_u32 s10, s10, 12288
    buffer_load_dwordx4 v15, s[48:51], s11 offen nt lds
    s_add_u32 s11, s11, 393216
    s_sub_u32 s12, s12, 1
    s_cmp_lg_u32 s12, 0
    s_cbranch_scc1 DMA_4
    s_barrier
    s_waitcnt vmcnt(0)
    s_branch X_B1
X_UKD:
    s_barrier
    s_mov_b32 exec_lo, 0xffffffff
    s_mov_b32 exec_hi, 0xffff
    s_mov_b32 s12, 4
DMA_5:
    s_mov_b32 m0, s68
    s_add_u32 s68, s68, 2400
    buffer_load_dwordx4 v14, s[52:55], s66 offen nt lds
    s_add_u32 s66, s66, 73728
    s_sub_u32 s12, s12, 1
    s_cmp_lg_u32 s12, 0
    s_cbranch_scc1 DMA_5
    s_mov_b64 exec, -1
X_B1:
    s_waitcnt lgkmcnt(0)
    s_mul_i32 s6, s6, 1664525
    s_add_u32 s6, s6, 1013904223
    v_mov_b32 v4, s6
    s_waitcnt lgkmcnt(0)
    s_barrier
    s_cmp_ge_u32 s3, 12
    s_cbranch_scc1 X_UK2
    v_mul_u32_u24 v5, 3072, v2
    v_lshl_add_u32 v5, v3, 3, v5
    s_lshl_b32 s9, s3, 7
    v_add_u32 v13, s9, v5
    s_mul_i32 s9, s8, 320
    s_add_u32 s9, s9, 147456
    v_lshl_add_u32 v6, v2, 4, s9
    ds_read_b128 v[64:67], v6 offset:0
    ds_read_b64_tr_b16 v[40:41], v13 offset:0
    ds_read_b64_tr_b16 v[42:43], v13 offset:1536
    ds_read_b128 v[68:71], v6 offset:64
    ds_read_b64_tr_b16 v[44:45], v13 offset:12288
    ds_read_b64_tr_b16 v[46:47], v13 offset:13824
    ds_read_b128 v[72:75], v6 offset:128
    ds_read_b64_tr_b16 v[48:49], v13 offset:24576
    ds_read_b64_tr_b16 v[50:51], v13 offset:26112
    ds_read_b128 v[76:79], v6 offset:192
    ds_read_b64_tr_b16 v[52:53], v13 offset:36864
    ds_read_b64_tr_b16 v[54:55], v13 offset:38400
    ds_read_b128 v[80:83], v6 offset:256
    ds_read_b64_tr_b16 v[56:57], v13 offset:49152
    ds_read_b64_tr_b16 v[58:59], v13 offset:50688
    s_lshl_b32 s9, s7, 2
    s_add_u32 s9, s9, s8
    s_mul_i32 s9, s9, 1536
    s_lshl_b32 s10, s3, 7
    s_add_u32 s9, s9, s10
    s_add_u32 s9, s9, 65536
    v_lshlrev_b32 v5, 3, v3
    s_waitcnt lgkmcnt(12)
    v_mfma_f32_16x16x32_bf16 v[88:91], v[64:67], v[40:43], 0
    s_waitcnt lgkmcnt(9)
    v_mfma_f32_16x16x32_bf16 v[88:91], v[68:71], v[44:47], v[88:91]
    s_waitcnt lgkmcnt(6)
    v_mfma_f32_16x16x32_bf16 v[88:91], v[72:75], v[48:51], v[88:91]
    s_waitcnt lgkmcnt(3)
    v_mfma_f32_16x16x32_bf16 v[88:91], v[76:79], v[52:55], v[88:91]
    s_waitcnt lgkmcnt(0)
    v_mfma_f32_16x16x32_bf16 v[88:91], v[80:83], v[56:59], v[88:91]
    s_nop 7
    v_mov_b32 v89, v4
    s_mov_b64 exec, 0xffff
    s_add_u32 s10, s9, 6225920
    buffer_store_dwordx2 v[88:89], v5, s[44:47], s10 offen
    buffer_store_dwordx2 v[88:89], v5, s[44:47], s9 offen sc1
    s_mov_b64 exec, -1
    v_lshlrev_b32 v8, 4, v2
    v_add_u32 v8, 148736, v8
    v_lshrrev_b32 v7, 1, v3
    v_mul_u32_u24 v7, 800, v7
    v_and_b32 v9, 1, v3
    v_mul_u32_u24 v9, 384, v9
    v_add_u32 v7, v7, v9
    v_lshl_add_u32 v7, v2, 4, v7
    s_mul_i32 s9, s3, 6400
    s_add_u32 s9, s9, 61440
    v_add_u32 v7, s9, v7
    v_lshlrev_b32 v9, 3, v2
    s_lshl_b32 s9, s3, 5
    s_add_u32 s9, s9, 162304
    v_add_u32 v9, s9, v9
    v_mul_u32_u24 v10, 12, v1
    v_add_u32 v10, 162304, v10
    v_lshlrev_b32 v11, 4, v1
    s_lshl_b32 s9, s7, 11
    s_lshl_b32 s10, s8, 9
    s_add_u32 s9, s9, s10
    s_add_u32 s9, s9, 262144
    s_mov_b32 s70, s9
    s_branch X_B3
X_UK2:
    s_cmp_eq_u32 s3, 15
    s_cbranch_scc1 X_B3
    s_mov_b32 exec_lo, 0xffffffff
    s_mov_b32 exec_hi, 0xffff
    s_mov_b32 s12, 28
DMA_6:
    s_mov_b32 m0, s68
    s_add_u32 s68, s68, 2400
    buffer_load_dwordx4 v14, s[52:55], s66 offen nt lds
    s_add_u32 s66, s66, 73728
    s_sub_u32 s12, s12, 1
    s_cmp_lg_u32 s12, 0
    s_cbranch_scc1 DMA_6
    s_mov_b64 exec, -1
    s_cmp_ge_u32 s3, 14
    s_cbranch_scc1 X_B3W
    s_sub_u32 s9, s3, 12
    s_lshl_b32 s9, s9, 6
    v_add_u32 v5, s9, v1
    v_cmp_gt_u32 vcc, 96, v5
    s_and_saveexec_b64 s[42:43], vcc
    v_lshlrev_b32 v6, 4, v5
    s_mul_i32 s9, s7, 6144
    s_add_u32 s9, s9, 65536
    s_add_u32 s10, s9, 3072
    s_add_u32 s11, s9, 6225920
    s_add_u32 s69, s10, 6225920
    s_mov_b32 s13, 0
POLL_7:
    buffer_load_dwordx4 v[92:95], v6, s[44:47], s11 offen sc1
    buffer_load_dwordx4 v[96:99], v6, s[44:47], s11 offen offset:1536 sc1
    buffer_load_dwordx4 v[100:103], v6, s[44:47], s69 offen sc1
    buffer_load_dwordx4 v[104:107], v6, s[44:47], s69 offen offset:1536 sc1
    s_waitcnt vmcnt(0)
    v_xor_b32 v109, s6, v93
    v_xor_b32 v110, s6, v95
    v_or_b32 v108, v109, v110
    v_xor_b32 v109, s6, v97
    v_xor_b32 v110, s6, v99
    v_or3_b32 v108, v109, v110, v108
    v_xor_b32 v109, s6, v101
    v_xor_b32 v110, s6, v103
    v_or3_b32 v108, v109, v110, v108
    v_xor_b32 v109, s6, v105
    v_xor_b32 v110, s6, v107
    v_or3_b32 v108, v109, v110, v108
    v_cmp_ne_u32 vcc, 0, v108
    s_cmp_eq_u64 vcc, 0
    s_cbranch_scc1 PDONE_8
    buffer_load_dwordx4 v[92:95], v6, s[44:47], s9 offen sc1
    buffer_load_dwordx4 v[96:99], v6, s[44:47], s9 offen offset:1536 sc1
    buffer_load_dwordx4 v[100:103], v6, s[44:47], s10 offen sc1
    buffer_load_dwordx4 v[104:107], v6, s[44:47], s10 offen offset:1536 sc1
    s_waitcnt vmcnt(0)
    v_xor_b32 v109, s6, v93
    v_xor_b32 v110, s6, v95
    v_or_b32 v108, v109, v110
    v_xor_b32 v109, s6, v97
    v_xor_b32 v110, s6, v99
    v_or3_b32 v108, v109, v110, v108
    v_xor_b32 v109, s6, v101
    v_xor_b32 v110, s6, v103
    v_or3_b32 v108, v109, v110, v108
    v_xor_b32 v109, s6, v105
    v_xor_b32 v110, s6, v107
    v_or3_b32 v108, v109, v110, v108
    v_cmp_ne_u32 vcc, 0, v108
    s_cmp_eq_u64 vcc, 0
    s_cbranch_scc1 PDONE_8
    s_add_u32 s13, s13, 1
    s_cmp_lt_u32 s13, 65536
    s_cbranch_scc1 POLL_7
PDONE_8:
    v_add_f32 v92, v92, v96
    v_add_f32 v94, v94, v98
    v_add_f32 v100, v100, v104
    v_add_f32 v102, v102, v106
    v_add_f32 v92, v92, v100
    v_add_f32 v94, v94, v102
    v_mul_f32 v92, 0x3dd53b95, v92
    v_mul_f32 v94, 0x3dd53b95, v94
    v_cvt_pk_bf16_f32 v92, v92, v94
    v_lshlrev_b32 v6, 2, v5
    v_add_u32 v6, 148736, v6
    ds_write_b32 v6, v92
    s_mov_b64 exec, s[42:43]
X_B3W:
    s_waitcnt vmcnt(0)
X_B3:
    s_waitcnt lgkmcnt(0)
    s_barrier
    s_cmp_ge_u32 s3, 12
    s_cbranch_scc1 X_P2B
    ds_read_b128 v[16:19], v7 offset:0
    ds_read_b128 v[64:67], v8 offset:0
    ds_read_b128 v[20:23], v7 offset:64
    ds_read_b128 v[68:71], v8 offset:64
    ds_read_b128 v[24:27], v7 offset:128
    ds_read_b128 v[72:75], v8 offset:128
    ds_read_b128 v[28:31], v7 offset:192
    ds_read_b128 v[76:79], v8 offset:192
    ds_read_b128 v[32:35], v7 offset:256
    ds_read_b128 v[80:83], v8 offset:256
    ds_read_b128 v[36:39], v7 offset:320
    ds_read_b128 v[84:87], v8 offset:320
    s_waitcnt lgkmcnt(10)
    v_mfma_f32_16x16x32_bf16 v[88:91], v[16:19], v[64:67], 0
    s_waitcnt lgkmcnt(8)
    v_mfma_f32_16x16x32_bf16 v[88:91], v[20:23], v[68:71], v[88:91]
    s_waitcnt lgkmcnt(6)
    v_mfma_f32_16x16x32_bf16 v[88:91], v[24:27], v[72:75], v[88:91]
    s_waitcnt lgkmcnt(4)
    v_mfma_f32_16x16x32_bf16 v[88:91], v[28:31], v[76:79], v[88:91]
    s_waitcnt lgkmcnt(2)
    v_mfma_f32_16x16x32_bf16 v[88:91], v[32:35], v[80:83], v[88:91]
    s_waitcnt lgkmcnt(0)
    v_mfma_f32_16x16x32_bf16 v[88:91], v[36:39], v[84:87], v[88:91]
    s_nop 7
    v_cvt_pk_bf16_f32 v124, v88, v89
    v_cvt_pk_bf16_f32 v125, v90, v91
    s_mov_b32 exec_lo, 0x10001
    s_mov_b32 exec_hi, 0x10001
    ds_write_b64 v9, v[124:125]
    s_mov_b64 exec, -1
X_P2B:
    s_waitcnt lgkmcnt(0)
    s_barrier
    s_cmp_lg_u32 s3, 0
    s_cbranch_scc1 CST_9
    s_mov_b32 exec_lo, 0xffffffff
    s_mov_b32 exec_hi, 0x0
    ds_read2_b32 v[124:125], v10 offset1:1
    ds_read_b32 v126, v10 offset:8
    s_waitcnt lgkmcnt(0)
    v_bitop3_b32 v127, v124, v125, v126 bitop3:0x96
    v_xor_b32 v127, v4, v127
    buffer_store_dwordx4 v[124:127], v11, s[44:47], s70 offen sc1
    s_mov_b64 exec, -1
CST_9:
    s_mov_b32 s48, s24
    s_mov_b32 s49, s25
    s_mov_b32 s50, 9437184
    s_mov_b32 s51, 0x00020000
    s_cmp_ge_u32 s3, 12
    s_cbranch_scc1 X_B4
    s_mul_i32 s10, s8, 192
    s_lshl_b32 s11, s64, 3
    s_add_u32 s10, s10, s11
    s_mul_i32 s11, s10, 12288
    s_add_u32 s11, s11, s67
    s_lshl_b32 s10, s3, 10
    s_add_u32 s10, s10, 0
    s_mov_b32 s12, 6
DMA_10:
    s_mov_b32 m0, s10
    s_add_u32 s10, s10, 12288
    buffer_load_dwordx4 v15, s[48:51], s11 offen nt lds
    s_add_u32 s11, s11, 393216
    s_sub_u32 s12, s12, 1
    s_cmp_lg_u32 s12, 0
    s_cbranch_scc1 DMA_10
X_B4:
    s_mov_b32 s52, s30
    s_mov_b32 s53, s31
    s_mov_b32 s54, 1966080
    s_mov_b32 s55, 0x00020000
    s_mov_b32 s60, s32
    s_mov_b32 s61, s33
    s_mov_b32 s62, 1966080
    s_mov_b32 s63, 0x00020000
    v_cmp_lt_u32 vcc, 23, v1
    v_subrev_u32 v7, 24, v1
    s_nop 0
    v_cndmask_b32 v8, v1, v7, vcc
    v_lshlrev_b32 v8, 4, v8
    v_mov_b32 v7, 3072
    v_cndmask_b32 v7, 0, v7, vcc
    v_add_u32 v8, v8, v7
    s_cmp_ge_u32 s3, 10
    s_cbranch_scc1 PFG_11
    s_mul_i32 s9, s5, 40
    s_lshl_b32 s10, s3, 2
    s_add_u32 s9, s9, s10
    s_mul_i32 s9, s9, 3072
    s_mul_i32 s10, s4, 384
    s_add_u32 s9, s9, s10
    s_add_u32 s10, s9, 6144
    s_mov_b32 exec_lo, 0xffffffff
    s_mov_b32 exec_hi, 0xffff
    buffer_load_dwordx4 v[120:123], v8, s[52:55], s9 offen
    buffer_load_dwordx4 v[120:123], v8, s[52:55], s10 offen
    buffer_load_dwordx4 v[120:123], v8, s[60:63], s9 offen
    buffer_load_dwordx4 v[120:123], v8, s[60:63], s10 offen
    s_mov_b64 exec, -1
PFG_11:
    s_cmp_lt_u32 s3, 10
    s_cbranch_scc1 PFD_12
    s_mov_b32 s52, s34
    s_mov_b32 s53, s35
    s_mov_b32 s54, 1966080
    s_mov_b32 s55, 0x00020000
    s_mul_i32 s9, s4, 192
    s_mul_i32 s10, s5, 12
    s_add_u32 s9, s9, s10
    s_mul_i32 s9, s9, 1280
    s_sub_u32 s10, s3, 10
    s_mul_i32 s10, s10, 2560
    s_add_u32 s9, s9, s10
    v_lshlrev_b32 v8, 4, v1
    buffer_load_dwordx4 v[120:123], v8, s[52:55], s9 offen
    buffer_load_dwordx4 v[120:123], v8, s[52:55], s9 offen offset:1024
    s_mov_b32 exec_lo, 0xffffffff
    s_mov_b32 exec_hi, 0x0
    buffer_load_dwordx4 v[120:123], v8, s[52:55], s9 offen offset:2048
    s_mov_b64 exec, -1
PFD_12:
    v_lshrrev_b32 v8, 5, v1
    s_lshl_b32 s9, s3, 1
    v_add_u32 v8, s9, v8
    v_and_b32 v9, 31, v1
    v_mul_u32_u24 v6, 2176, v8
    v_lshl_add_u32 v6, v9, 4, v6
    v_mul_u32_u24 v10, 400, v8
    v_mul_u32_u24 v11, 12, v9
    v_add_u32 v10, v10, v11
    v_add_u32 v118, 149504, v10
    s_waitcnt vmcnt(0)
    s_waitcnt lgkmcnt(0)
    s_barrier
    s_cmp_ge_u32 s3, 12
    s_cbranch_scc1 X_NPR
    ds_read_b64_tr_b16 v[40:41], v13 offset:0
    ds_read_b64_tr_b16 v[42:43], v13 offset:1536
    ds_read_b64_tr_b16 v[44:45], v13 offset:12288
    ds_read_b64_tr_b16 v[46:47], v13 offset:13824
    ds_read_b64_tr_b16 v[48:49], v13 offset:24576
    ds_read_b64_tr_b16 v[50:51], v13 offset:26112
    ds_read_b64_tr_b16 v[52:53], v13 offset:36864
    ds_read_b64_tr_b16 v[54:55], v13 offset:38400
    ds_read_b64_tr_b16 v[56:57], v13 offset:49152
    ds_read_b64_tr_b16 v[58:59], v13 offset:50688
    ds_read_b64_tr_b16 v[60:61], v13 offset:61440
    ds_read_b64_tr_b16 v[62:63], v13 offset:62976
X_NPR:
    v_lshrrev_b32 v16, 2, v3
    v_lshl_add_u32 v16, v2, 3, v16
    v_mul_u32_u24 v16, 400, v16
    v_and_b32 v17, 3, v3
    v_lshl_add_u32 v16, v17, 3, v16
    s_lshl_b32 s9, s3, 5
    s_add_u32 s10, s9, 149504
    v_add_u32 v16, s10, v16
    v_and_b32 v17, 1, v1
    v_lshlrev_b32 v17, 6, v17
    v_lshl_add_u32 v17, v2, 4, v17
    v_add_u32 v17, 162688, v17
    v_lshlrev_b32 v18, 1, v3
    s_add_u32 s10, s9, 162304
    v_add_u32 v18, s10, v18
    v_lshlrev_b32 v19, 4, v2
    v_add_u32 v19, 162304, v19
    v_lshlrev_b32 v20, 3, v2
    s_lshl_b32 s9, s3, 5
    s_add_u32 s9, s9, 148736
    v_add_u32 v20, s9, v20
    v_lshlrev_b32 v21, 3, v1
    v_add_u32 v21, 148736, v21
    v_lshlrev_b32 v22, 4, v1
    s_lshl_b32 s9, s4, 2
    s_add_u32 s9, s9, s8
    s_mul_i32 s9, s9, 3072
    s_and_b32 s10, s7, 3
    s_mul_i32 s10, s10, 768
    s_add_u32 s9, s9, s10
    s_add_u32 s9, s9, 458752
    s_mov_b32 s70, s9
    v_mov_b32 v23, 162816
    s_mul_i32 s9, s7, 69632
    s_add_u32 s69, s9, 2099200
    s_lshl_b32 s10, s8, 9
    s_add_u32 s9, s9, s10
    s_add_u32 s9, s9, 2097152
    s_cmp_eq_u32 s3, 12
    s_cbranch_scc1 X_ML
    s_mov_b32 s13, 0
    s_mov_b64 s[100:101], exec
    s_mov_b64 s[84:85], exec
POLL_13:
    s_mov_b64 exec, s[84:85]
    buffer_load_dwordx4 v[96:99], v6, s[44:47], s9 offen sc1
    s_waitcnt vmcnt(0)
    s_mov_b64 exec, s[84:85]
    v_bitop3_b32 v108, v96, v97, v98 bitop3:0x96
    v_bitop3_b32 v108, v108, v99, v4 bitop3:0x96
    v_cmp_ne_u32 vcc, 0, v108
    s_mov_b64 s[84:85], vcc
    s_mov_b64 s[14:15], vcc
    s_mov_b64 exec, s[100:101]
    s_add_u32 s13, s13, 1
    s_cmp_eq_u64 s[14:15], 0
    s_cbranch_scc1 PDONE_14
    s_cmp_lt_u32 s13, 65536
    s_cbranch_scc1 POLL_13
    s_mov_b64 exec, s[100:101]
PDONE_14:
    ds_write2_b32 v118, v96, v97 offset1:1
    ds_write_b32 v118, v98 offset:8
    s_cmp_lg_u32 s3, 13
    s_cbranch_scc1 HCK_16
    v_lshlrev_b32 v5, 3, v1
    s_lshl_b32 s10, s4, 8
    s_add_u32 s10, s10, 4224
    s_getreg_b32 s11, hwreg(HW_REG_XCC_ID, 0, 4)
    s_mov_b64 exec, 0x3ff
    buffer_load_dwordx2 v[100:101], v5, s[44:47], s10 offen sc1
    s_waitcnt vmcnt(0)
    v_xor_b32 v100, s11, v100
    v_xor_b32 v101, s6, v101
    v_or_b32 v100, v100, v101
    v_cmp_ne_u32 vcc, 0, v100
    s_cmp_eq_u64 vcc, 0
    s_cselect_b32 s10, 1, 0
    s_mov_b64 exec, 1
    v_mov_b32 v100, s10
    v_mov_b32 v5, 162816
    ds_write_b32 v5, v100
    s_mov_b64 exec, -1
HCK_16:
    s_branch X_B5
X_ML:
    v_and_b32 v5, 31, v1
    v_mul_u32_u24 v5, 2176, v5
    s_mov_b32 s13, 0
    s_mov_b64 s[100:101], exec
    s_mov_b64 s[84:85], exec
    s_mov_b32 s86, 0xffffffff
    s_mov_b32 s87, 0x0
POLL_17:
    s_mov_b64 exec, s[84:85]
    s_cbranch_execz PSK_19
    buffer_load_dwordx4 v[100:103], v6, s[44:47], s9 offen sc1
PSK_19:
    s_mov_b64 exec, s[86:87]
    s_cbranch_execz PSK_20
    buffer_load_dwordx4 v[96:99], v5, s[44:47], s69 offen sc1
PSK_20:
    s_waitcnt vmcnt(0)
    s_mov_b64 exec, s[84:85]
    v_bitop3_b32 v108, v100, v101, v102 bitop3:0x96
    v_bitop3_b32 v108, v108, v103, v4 bitop3:0x96
    v_cmp_ne_u32 vcc, 0, v108
    s_mov_b64 s[84:85], vcc
    s_mov_b64 s[14:15], vcc
    s_mov_b64 exec, s[86:87]
    v_bitop3_b32 v108, v96, v97, v98 bitop3:0x96
    v_bitop3_b32 v108, v108, v99, v4 bitop3:0x96
    v_cmp_ne_u32 vcc, 0, v108
    s_mov_b64 s[86:87], vcc
    s_or_b64 s[14:15], s[14:15], vcc
    s_mov_b64 exec, s[100:101]
    s_add_u32 s13, s13, 1
    s_cmp_eq_u64 s[14:15], 0
    s_cbranch_scc1 PDONE_18
    s_cmp_lt_u32 s13, 65536
    s_cbranch_scc1 POLL_17
    s_mov_b64 exec, s[100:101]
PDONE_18:
    ds_write2_b32 v118, v100, v101 offset1:1
    ds_write_b32 v118, v102 offset:8
    v_mov_b32 v98, v96
    s_nop 1
    s_nop 1
    v_max_f32_dpp v98, v98, v98 row_ror:8 row_mask:0xf bank_mask:0xf
    s_nop 1
    v_max_f32_dpp v98, v98, v98 row_ror:4 row_mask:0xf bank_mask:0xf
    s_nop 1
    v_max_f32_dpp v98, v98, v98 row_ror:2 row_mask:0xf bank_mask:0xf
    s_nop 1
    v_max_f32_dpp v98, v98, v98 row_ror:1 row_mask:0xf bank_mask:0xf
    s_nop 1
    v_mov_b32 v99, v98
    s_nop 1
    v_permlane16_swap_b32 v98, v99
    s_nop 1
    v_max_f32 v98, v98, v99
    v_sub_f32 v96, v96, v98
    v_exp_f32 v96, v96
    s_nop 0
    v_mul_f32 v97, v96, v97
    s_nop 1
    s_nop 1
    v_add_f32_dpp v97, v97, v97 row_ror:8 row_mask:0xf bank_mask:0xf
    s_nop 1
    v_add_f32_dpp v97, v97, v97 row_ror:4 row_mask:0xf bank_mask:0xf
    s_nop 1
    v_add_f32_dpp v97, v97, v97 row_ror:2 row_mask:0xf bank_mask:0xf
    s_nop 1
    v_add_f32_dpp v97, v97, v97 row_ror:1 row_mask:0xf bank_mask:0xf
    s_nop 1
    v_mov_b32 v99, v97
    s_nop 1
    v_permlane16_swap_b32 v97, v99
    s_nop 1
    v_add_f32 v97, v97, v99
    v_rcp_f32 v97, v97
    s_nop 0
    v_mul_f32 v96, v96, v97
    v_cvt_pk_bf16_f32 v97, v96, v96
    v_and_b32 v98, 0xffff0000, v97
    v_sub_f32 v96, v96, v98
    v_cvt_pk_bf16_f32 v96, v96, v96
    v_and_b32 v5, 31, v1
    v_lshlrev_b32 v5, 1, v5
    v_add_u32 v5, 162688, v5
    s_mov_b32 exec_lo, 0xffffffff
    s_mov_b32 exec_hi, 0x0
    ds_write_b16 v5, v97
    ds_write_b16 v5, v96 offset:64
    s_mov_b64 exec, -1
X_B5:
    s_waitcnt lgkmcnt(0)
    s_barrier
    s_cmp_ge_u32 s3, 12
    s_cbranch_scc1 X_B5b
    ds_read_b64_tr_b16 v[96:97], v16
    ds_read_b64_tr_b16 v[98:99], v16 offset:1600
    ds_read_b128 v[100:103], v17
    s_waitcnt lgkmcnt(0)
    v_mfma_f32_16x16x32_bf16 v[120:123], v[100:103], v[96:99], 0
    s_nop 7
    v_add_f32 v120, v120, v121
    v_cvt_pk_bf16_f32 v120, v120, v120
    s_mov_b64 exec, 0xffff
    ds_write_b16 v18, v120
    s_mov_b64 exec, -1
X_B5b:
    s_waitcnt lgkmcnt(0)
    s_barrier
    s_cmp_ge_u32 s3, 12
    s_cbranch_scc1 X_UPD
    ds_read_b128 v[96:99], v19 offset:0
    ds_read_b128 v[100:103], v19 offset:64
    ds_read_b128 v[104:107], v19 offset:128
    ds_read_b128 v[108:111], v19 offset:192
    ds_read_b128 v[112:115], v19 offset:256
    ds_read_b128 v[116:119], v19 offset:320
    s_waitcnt lgkmcnt(5)
    v_mfma_f32_16x16x32_bf16 v[120:123], v[40:43], v[96:99], 0
    s_waitcnt lgkmcnt(4)
    v_mfma_f32_16x16x32_bf16 v[120:123], v[44:47], v[100:103], v[120:123]
    s_waitcnt lgkmcnt(3)
    v_mfma_f32_16x16x32_bf16 v[120:123], v[48:51], v[104:107], v[120:123]
    s_waitcnt lgkmcnt(2)
    v_mfma_f32_16x16x32_bf16 v[120:123], v[52:55], v[108:111], v[120:123]
    s_waitcnt lgkmcnt(1)
    v_mfma_f32_16x16x32_bf16 v[120:123], v[56:59], v[112:115], v[120:123]
    s_waitcnt lgkmcnt(0)
    v_mfma_f32_16x16x32_bf16 v[120:123], v[60:63], v[116:119], v[120:123]
    s_nop 7
    v_cvt_pk_bf16_f32 v124, v120, v121
    v_cvt_pk_bf16_f32 v125, v122, v123
    s_mov_b32 exec_lo, 0x10001
    s_mov_b32 exec_hi, 0x10001
    ds_write_b64 v20, v[124:125]
    s_mov_b64 exec, -1
X_UPD:
    s_waitcnt lgkmcnt(0)
    s_barrier
    s_cmp_lg_u32 s3, 0
    s_cbranch_scc1 CST_21
    s_mov_b32 exec_lo, 0xffffffff
    s_mov_b32 exec_hi, 0xffff
    ds_read_b64 v[124:125], v21
    ds_read_b32 v123, v23
    s_waitcnt lgkmcnt(0)
    v_mov_b32 v126, v125
    v_mov_b32 v125, v4
    v_mov_b32 v127, v4
    s_nop 0
    v_readfirstlane_b32 s10, v123
    s_nop 3
    s_cmp_eq_u32 s10, 1
    s_cbranch_scc0 STG_22
    buffer_store_dwordx4 v[124:127], v22, s[44:47], s70 offen
    s_branch STD_23
STG_22:
    buffer_store_dwordx4 v[124:127], v22, s[44:47], s70 offen sc1
STD_23:
    s_mov_b64 exec, -1
CST_21:
    s_cmp_ge_u32 s5, 5
    s_cbranch_scc1 X_END
    s_mul_i32 s66, s4, 5
    s_add_u32 s66, s66, s5
    s_cmp_ge_u32 s3, 7
    s_cbranch_scc1 X_B9
    s_cmp_eq_u32 s3, 6
    s_cbranch_scc1 X_FH
    v_lshrrev_b32 v5, 3, v1
    v_mul_u32_u24 v5, 5120, v5
    v_and_b32 v6, 7, v1
    v_lshl_add_u32 v5, v6, 4, v5
    s_mul_i32 s9, s3, 40960
    s_lshl_b32 s10, s66, 7
    s_add_u32 s9, s9, s10
    s_add_u32 s9, s9, 1048576
    s_mov_b32 s13, 0
    s_mov_b64 s[100:101], exec
    s_mov_b64 s[84:85], exec
POLL_24:
    s_mov_b64 exec, s[84:85]
    buffer_load_dwordx4 v[92:95], v5, s[44:47], s9 offen sc1
    s_waitcnt vmcnt(0)
    s_mov_b64 exec, s[84:85]
    v_xor_b32 v108, s6, v93
    v_xor_b32 v109, s6, v95
    v_or_b32 v108, v108, v109
    v_cmp_ne_u32 vcc, 0, v108
    s_mov_b64 s[84:85], vcc
    s_mov_b64 s[14:15], vcc
    s_mov_b64 exec, s[100:101]
    s_add_u32 s13, s13, 1
    s_cmp_eq_u64 s[14:15], 0
    s_cbranch_scc1 PDONE_25
    s_cmp_lt_u32 s13, 65536
    s_cbranch_scc1 POLL_24
    s_mov_b64 exec, s[100:101]
PDONE_25:
    v_mov_b32 v93, v94
    s_nop 1
    v_add_f32_dpp v92, v92, v92 row_ror:8 row_mask:0xf bank_mask:0xf
    v_add_f32_dpp v93, v93, v93 row_ror:8 row_mask:0xf bank_mask:0xf
    v_mov_b32 v96, v92
    s_nop 1
    v_permlane16_swap_b32 v92, v96
    s_nop 1
    v_add_f32 v92, v92, v96
    v_mov_b32 v96, v92
    s_nop 1
    v_permlane32_swap_b32 v92, v96
    s_nop 1
    v_add_f32 v92, v92, v96
    v_mov_b32 v96, v93
    s_nop 1
    v_permlane16_swap_b32 v93, v96
    s_nop 1
    v_add_f32 v93, v93, v96
    v_mov_b32 v96, v93
    s_nop 1
    v_permlane32_swap_b32 v93, v96
    s_nop 1
    v_add_f32 v93, v93, v96
    v_lshlrev_b32 v6, 3, v6
    s_lshl_b32 s9, s3, 6
    s_add_u32 s9, s9, 153856
    v_add_u32 v6, s9, v6
    s_mov_b64 exec, 0xff
    ds_write_b64 v6, v[92:93]
    s_mov_b64 exec, -1
    s_branch X_B9
X_FH:
    v_bfe_u32 v5, v1, 2, 3
    v_mul_u32_u24 v5, 2560, v5
    v_and_b32 v6, 3, v1
    v_lshl_add_u32 v5, v6, 4, v5
    s_lshl_b32 s9, s66, 6
    s_add_u32 s9, s9, 589824
    v_lshlrev_b32 v7, 3, v6
    s_lshl_b32 s10, s66, 5
    buffer_load_dwordx2 v[104:105], v7, s[56:59], s10 offen
    s_mov_b32 exec_lo, 0xffffffff
    s_mov_b32 exec_hi, 0x0
    s_mov_b32 s13, 0
    s_mov_b64 s[100:101], exec
    s_mov_b64 s[84:85], exec
POLL_27:
    s_mov_b64 exec, s[84:85]
    buffer_load_dwordx4 v[92:95], v5, s[44:47], s9 offen sc1
    s_waitcnt vmcnt(0)
    s_mov_b64 exec, s[84:85]
    v_xor_b32 v108, s6, v93
    v_xor_b32 v109, s6, v95
    v_or_b32 v108, v108, v109
    v_cmp_ne_u32 vcc, 0, v108
    s_mov_b64 s[84:85], vcc
    s_mov_b64 s[14:15], vcc
    s_mov_b64 exec, s[100:101]
    s_add_u32 s13, s13, 1
    s_cmp_eq_u64 s[14:15], 0
    s_cbranch_scc1 PDONE_28
    s_cmp_lt_u32 s13, 65536
    s_cbranch_scc1 POLL_27
    s_mov_b64 exec, s[100:101]
PDONE_28:
    s_mov_b64 exec, -1
    v_lshlrev_b32 v96, 16, v92
    v_and_b32 v97, 0xffff0000, v92
    v_lshlrev_b32 v98, 16, v94
    v_and_b32 v99, 0xffff0000, v94
    s_nop 1
    v_add_f32_dpp v96, v96, v96 row_ror:4 row_mask:0xf bank_mask:0xf
    v_add_f32_dpp v97, v97, v97 row_ror:4 row_mask:0xf bank_mask:0xf
    v_add_f32_dpp v98, v98, v98 row_ror:4 row_mask:0xf bank_mask:0xf
    v_add_f32_dpp v99, v99, v99 row_ror:4 row_mask:0xf bank_mask:0xf
    v_add_f32_dpp v96, v96, v96 row_ror:8 row_mask:0xf bank_mask:0xf
    v_add_f32_dpp v97, v97, v97 row_ror:8 row_mask:0xf bank_mask:0xf
    v_add_f32_dpp v98, v98, v98 row_ror:8 row_mask:0xf bank_mask:0xf
    v_add_f32_dpp v99, v99, v99 row_ror:8 row_mask:0xf bank_mask:0xf
    v_mov_b32 v100, v96
    s_nop 1
    v_permlane16_swap_b32 v96, v100
    s_nop 1
    v_add_f32 v96, v96, v100
    v_mov_b32 v100, v97
    s_nop 1
    v_permlane16_swap_b32 v97, v100
    s_nop 1
    v_add_f32 v97, v97, v100
    v_mov_b32 v100, v98
    s_nop 1
    v_permlane16_swap_b32 v98, v100
    s_nop 1
    v_add_f32 v98, v98, v100
    v_mov_b32 v100, v99
    s_nop 1
    v_permlane16_swap_b32 v99, v100
    s_nop 1
    v_add_f32 v99, v99, v100
    v_lshlrev_b32 v100, 16, v104
    v_and_b32 v101, 0xffff0000, v104
    v_lshlrev_b32 v102, 16, v105
    v_and_b32 v103, 0xffff0000, v105
    v_add_f32 v96, v96, v100
    v_add_f32 v97, v97, v101
    v_add_f32 v98, v98, v102
    v_add_f32 v99, v99, v103
    v_lshlrev_b32 v6, 4, v6
    v_add_u32 v6, 149504, v6
    s_mov_b64 exec, 0xf
    ds_write_b128 v6, v[96:99]
    s_mov_b64 exec, -1
X_B9:
    s_waitcnt lgkmcnt(0)
    s_barrier
    s_cmp_lg_u32 s3, 0
    s_cbranch_scc1 X_END
    v_lshlrev_b32 v5, 3, v1
    v_add_u32 v6, 153856, v5
    v_add_u32 v7, 149504, v5
    s_mov_b64 exec, 0xff
    ds_read_b64 v[92:93], v6 offset:0
    ds_read_b64 v[94:95], v6 offset:64
    ds_read_b64 v[96:97], v6 offset:128
    ds_read_b64 v[98:99], v6 offset:192
    ds_read_b64 v[100:101], v6 offset:256
    ds_read_b64 v[102:103], v6 offset:320
    ds_read_b64 v[116:117], v7
    s_mov_b32 s60, s36
    s_mov_b32 s61, s37
    s_mov_b32 s62, 1280
    s_mov_b32 s63, 0x00020000
    s_waitcnt lgkmcnt(0)
    v_add_f32 v92, v92, v94
    v_add_f32 v93, v93, v95
    v_add_f32 v92, v92, v96
    v_add_f32 v93, v93, v97
    v_add_f32 v92, v92, v98
    v_add_f32 v93, v93, v99
    v_add_f32 v92, v92, v100
    v_add_f32 v93, v93, v101
    v_add_f32 v92, v92, v102
    v_add_f32 v93, v93, v103
    v_add_f32 v92, v92, v116
    v_add_f32 v93, v93, v117
    v_cvt_pk_bf16_f32 v92, v92, v93
    v_lshlrev_b32 v5, 2, v1
    s_lshl_b32 s9, s66, 5
    buffer_store_dword v92, v5, s[60:63], s9 offen
    s_cmp_lg_u32 s66, 0
    s_cbranch_scc1 X_EP
    s_mov_b64 exec, 1
    v_mov_b32 v5, 0
    buffer_store_dword v4, v5, s[44:47], 0 offen sc1
X_EP:
    s_mov_b64 exec, -1
X_END:
    s_endpgm
X_LN:
    s_waitcnt vmcnt(0)
    v_lshlrev_b32 v21, 16, v16
    v_and_b32 v22, 0xffff0000, v16
    v_lshlrev_b32 v23, 16, v17
    v_and_b32 v24, 0xffff0000, v17
    v_lshlrev_b32 v25, 16, v18
    v_and_b32 v26, 0xffff0000, v18
    v_lshlrev_b32 v27, 16, v19
    v_and_b32 v28, 0xffff0000, v19
    v_lshlrev_b32 v29, 16, v20
    v_and_b32 v30, 0xffff0000, v20
    v_add_f32 v31, v21, v22
    v_add_f32 v31, v31, v23
    v_add_f32 v31, v31, v24
    v_add_f32 v31, v31, v25
    v_add_f32 v31, v31, v26
    v_add_f32 v31, v31, v27
    v_add_f32 v31, v31, v28
    v_add_f32 v31, v31, v29
    v_add_f32 v31, v31, v30
    s_nop 1
    s_nop 1
    v_add_f32_dpp v31, v31, v31 row_ror:8 row_mask:0xf bank_mask:0xf
    s_nop 1
    v_add_f32_dpp v31, v31, v31 row_ror:4 row_mask:0xf bank_mask:0xf
    s_nop 1
    v_add_f32_dpp v31, v31, v31 row_ror:2 row_mask:0xf bank_mask:0xf
    s_nop 1
    v_add_f32_dpp v31, v31, v31 row_ror:1 row_mask:0xf bank_mask:0xf
    s_nop 1
    v_mov_b32 v32, v31
    s_nop 1
    v_permlane16_swap_b32 v31, v32
    s_nop 1
    v_add_f32 v31, v31, v32
    v_mov_b32 v32, v31
    s_nop 1
    v_permlane32_swap_b32 v31, v32
    s_nop 1
    v_add_f32 v31, v31, v32
    v_mul_f32 v31, 0x3acccccd, v31
    v_sub_f32 v21, v21, v31
    v_sub_f32 v22, v22, v31
    v_sub_f32 v23, v23, v31
    v_sub_f32 v24, v24, v31
    v_sub_f32 v25, v25, v31
    v_sub_f32 v26, v26, v31
    v_sub_f32 v27, v27, v31
    v_sub_f32 v28, v28, v31
    v_sub_f32 v29, v29, v31
    v_sub_f32 v30, v30, v31
    v_mul_f32 v33, v21, v21
    v_fmac_f32 v33, v22, v22
    v_fmac_f32 v33, v23, v23
    v_fmac_f32 v33, v24, v24
    v_fmac_f32 v33, v25, v25
    v_fmac_f32 v33, v26, v26
    v_fmac_f32 v33, v27, v27
    v_fmac_f32 v33, v28, v28
    v_fmac_f32 v33, v29, v29
    v_fmac_f32 v33, v30, v30
    s_nop 1
    s_nop 1
    v_add_f32_dpp v33, v33, v33 row_ror:8 row_mask:0xf bank_mask:0xf
    s_nop 1
    v_add_f32_dpp v33, v33, v33 row_ror:4 row_mask:0xf bank_mask:0xf
    s_nop 1
    v_add_f32_dpp v33, v33, v33 row_ror:2 row_mask:0xf bank_mask:0xf
    s_nop 1
    v_add_f32_dpp v33, v33, v33 row_ror:1 row_mask:0xf bank_mask:0xf
    s_nop 1
    v_mov_b32 v32, v33
    s_nop 1
    v_permlane16_swap_b32 v33, v32
    s_nop 1
    v_add_f32 v33, v33, v32
    v_mov_b32 v32, v33
    s_nop 1
    v_permlane32_swap_b32 v33, v32
    s_nop 1
    v_add_f32 v33, v33, v32
    v_mov_b32 v32, 0x3727c5ac
    v_fmac_f32 v32, 0x3acccccd, v33
    v_rsq_f32 v32, v32
    s_nop 0
    v_mul_f32 v21, v21, v32
    v_mul_f32 v22, v22, v32
    v_mul_f32 v23, v23, v32
    v_mul_f32 v24, v24, v32
    v_mul_f32 v25, v25, v32
    v_mul_f32 v26, v26, v32
    v_mul_f32 v27, v27, v32
    v_mul_f32 v28, v28, v32
    v_mul_f32 v29, v29, v32
    v_mul_f32 v30, v30, v32
    v_cvt_pk_bf16_f32 v16, v21, v22
    v_cvt_pk_bf16_f32 v17, v23, v24
    v_cvt_pk_bf16_f32 v18, v25, v26
    v_cvt_pk_bf16_f32 v19, v27, v28
    v_cvt_pk_bf16_f32 v20, v29, v30
    v_add_u32 v5, 147456, v5
    ds_write_b32 v5, v16 offset:0
    ds_write_b32 v5, v17 offset:256
    ds_write_b32 v5, v18 offset:512
    ds_write_b32 v5, v19 offset:768
    ds_write_b32 v5, v20 offset:1024
    s_branch X_B1
L_Y:
    s_sub_u32 s5, s5, 16
    s_and_b32 s7, s5, 3
    s_lshr_b32 s8, s5, 2
    v_bfe_u32 v5, v1, 1, 2
    v_mul_u32_u24 v5, 1536, v5
    v_lshrrev_b32 v6, 3, v1
    v_lshl_add_u32 v5, v6, 5, v5
    v_and_b32 v6, 1, v1
    v_lshl_add_u32 v15, v6, 4, v5
    s_lshl_b32 s9, s4, 9
    s_lshl_b32 s10, s8, 7
    s_add_u32 s9, s9, s10
    s_mul_i32 s10, s3, 43
    s_lshr_b32 s10, s10, 8
    s_mul_i32 s11, s10, 6
    s_sub_u32 s11, s3, s11
    s_lshl_b32 s14, s10, 2
    s_add_u32 s9, s9, s14
    s_mul_i32 s66, s9, 1536
    s_lshl_b32 s14, s11, 8
    s_add_u32 s66, s66, s14
    s_mul_i32 s67, s10, 6272
    s_lshl_b32 s14, s11, 10
    s_add_u32 s67, s67, s14
    s_waitcnt lgkmcnt(0)
    s_load_dword s6, s[40:41], 0
    s_mov_b32 s44, s40
    s_mov_b32 s45, s41
    s_mov_b32 s46, 7340032
    s_mov_b32 s47, 0x00020000
    s_mov_b32 s48, s18
    s_mov_b32 s49, s19
    s_mov_b32 s50, 6291456
    s_mov_b32 s51, 0x00020000
    s_cmp_ge_u32 s3, 12
    s_cbranch_scc1 YCD_30
    s_add_u32 s10, s67, 0
    s_add_u32 s11, s66, 0
    s_mov_b32 m0, s10
    s_add_u32 s10, s10, 12544
    buffer_load_dwordx4 v15, s[48:51], s11 offen nt lds
    s_add_u32 s11, s11, 12288
    s_mov_b32 m0, s10
    s_add_u32 s10, s10, 12544
    buffer_load_dwordx4 v15, s[48:51], s11 offen nt lds
    s_add_u32 s11, s11, 12288
YCD_30:
    s_cmp_ge_u32 s3, 12
    s_cbranch_scc1 YCD_31
    s_add_u32 s10, s67, 25088
    s_add_u32 s11, s66, 24576
    s_mov_b32 m0, s10
    s_add_u32 s10, s10, 12544
    buffer_load_dwordx4 v15, s[48:51], s11 offen nt lds
    s_add_u32 s11, s11, 12288
    s_mov_b32 m0, s10
    s_add_u32 s10, s10, 12544
    buffer_load_dwordx4 v15, s[48:51], s11 offen nt lds
    s_add_u32 s11, s11, 12288
YCD_31:
    s_cmp_ge_u32 s3, 12
    s_cbranch_scc1 YCD_32
    s_add_u32 s10, s67, 50176
    s_add_u32 s11, s66, 49152
    s_mov_b32 m0, s10
    s_add_u32 s10, s10, 12544
    buffer_load_dwordx4 v15, s[48:51], s11 offen nt lds
    s_add_u32 s11, s11, 12288
    s_mov_b32 m0, s10
    s_add_u32 s10, s10, 12544
    buffer_load_dwordx4 v15, s[48:51], s11 offen nt lds
    s_add_u32 s11, s11, 12288
YCD_32:
    v_lshlrev_b32 v5, 2, v0
    v_add_u32 v5, 147584, v5
    v_mov_b32 v6, 0
    ds_write_b32 v5, v6
    s_and_b32 s68, s3, 3
    s_lshr_b32 s69, s3, 2
    v_lshrrev_b32 v5, 2, v3
    v_mul_u32_u24 v5, 6272, v5
    v_and_b32 v6, 3, v3
    v_lshl_add_u32 v5, v6, 5, v5
    v_lshrrev_b32 v6, 1, v2
    v_lshl_add_u32 v5, v6, 7, v5
    v_and_b32 v6, 1, v2
    v_lshl_add_u32 v5, v6, 4, v5
    s_mul_i32 s9, s69, 1536
    v_add_u32 v13, s9, v5
    v_mul_u32_u24 v5, 6272, v2
    v_lshl_add_u32 v5, v3, 3, v5
    s_mul_i32 s9, s3, 384
    v_add_u32 v14, s9, v5
    v_add_u32 v8, 50176, v14
    v_add_u32 v11, 50176, v13
    v_lshlrev_b32 v6, 4, v1
    s_and_b32 s9, s3, 1
    s_lshl_b32 s9, s9, 6
    v_add_u32 v9, s9, v1
    v_mul_u32_u24 v9, 12, v9
    s_lshr_b32 s9, s3, 1
    s_mul_i32 s9, s9, 1552
    s_add_u32 s9, s9, 100352
    v_add_u32 v9, s9, v9
    s_waitcnt vmcnt(4)
    s_waitcnt lgkmcnt(0)
    s_barrier
    s_cmp_ge_u32 s3, 12
    s_cbranch_scc1 YCD_33
    s_add_u32 s10, s67, 75264
    s_add_u32 s11, s66, 73728
    s_mov_b32 m0, s10
    s_add_u32 s10, s10, 12544
    buffer_load_dwordx4 v15, s[48:51], s11 offen nt lds
    s_add_u32 s11, s11, 12288
    s_mov_b32 m0, s10
    s_add_u32 s10, s10, 12544
    buffer_load_dwordx4 v15, s[48:51], s11 offen nt lds
    s_add_u32 s11, s11, 12288
YCD_33:
    s_cmp_lg_u32 s68, 0
    s_cbranch_scc1 YSR_34
    ds_read_b128 v[16:19], v13 offset:0
    ds_read_b128 v[20:23], v13 offset:256
    ds_read_b128 v[24:27], v13 offset:512
    ds_read_b128 v[28:31], v13 offset:768
    ds_read_b128 v[32:35], v13 offset:1024
    ds_read_b128 v[36:39], v13 offset:1280
YSR_34:
    ds_read_b64_tr_b16 v[64:65], v14 offset:0
    ds_read_b64_tr_b16 v[68:69], v14 offset:128
    ds_read_b64_tr_b16 v[72:73], v14 offset:256
    s_waitcnt vmcnt(4)
    s_waitcnt lgkmcnt(0)
    s_barrier
    s_cmp_ge_u32 s3, 12
    s_cbranch_scc1 YCD_35
    s_add_u32 s10, s67, 0
    s_add_u32 s11, s66, 98304
    s_mov_b32 m0, s10
    s_add_u32 s10, s10, 12544
    buffer_load_dwordx4 v15, s[48:51], s11 offen nt lds
    s_add_u32 s11, s11, 12288
    s_mov_b32 m0, s10
    s_add_u32 s10, s10, 12544
    buffer_load_dwordx4 v15, s[48:51], s11 offen nt lds
    s_add_u32 s11, s11, 12288
YCD_35:
    s_cmp_lg_u32 s68, 0
    s_cbranch_scc1 YSR_36
    ds_read_b128 v[40:43], v13 offset:25088
    ds_read_b128 v[44:47], v13 offset:25344
    ds_read_b128 v[48:51], v13 offset:25600
    ds_read_b128 v[52:55], v13 offset:25856
    ds_read_b128 v[56:59], v13 offset:26112
    ds_read_b128 v[60:63], v13 offset:26368
YSR_36:
    ds_read_b64_tr_b16 v[66:67], v14 offset:25088
    ds_read_b64_tr_b16 v[70:71], v14 offset:25216
    ds_read_b64_tr_b16 v[74:75], v14 offset:25344
    s_waitcnt vmcnt(4)
    s_waitcnt lgkmcnt(0)
    s_barrier
    s_cmp_ge_u32 s3, 12
    s_cbranch_scc1 YCD_37
    s_add_u32 s10, s67, 25088
    s_add_u32 s11, s66, 122880
    s_mov_b32 m0, s10
    s_add_u32 s10, s10, 12544
    buffer_load_dwordx4 v15, s[48:51], s11 offen nt lds
    s_add_u32 s11, s11, 12288
    s_mov_b32 m0, s10
    s_add_u32 s10, s10, 12544
    buffer_load_dwordx4 v15, s[48:51], s11 offen nt lds
    s_add_u32 s11, s11, 12288
YCD_37:
    s_cmp_lg_u32 s68, 1
    s_cbranch_scc1 YSR_38
    ds_read_b128 v[16:19], v11 offset:0
    ds_read_b128 v[20:23], v11 offset:256
    ds_read_b128 v[24:27], v11 offset:512
    ds_read_b128 v[28:31], v11 offset:768
    ds_read_b128 v[32:35], v11 offset:1024
    ds_read_b128 v[36:39], v11 offset:1280
YSR_38:
    ds_read_b64_tr_b16 v[76:77], v8 offset:0
    ds_read_b64_tr_b16 v[80:81], v8 offset:128
    ds_read_b64_tr_b16 v[84:85], v8 offset:256
    s_waitcnt vmcnt(4)
    s_waitcnt lgkmcnt(0)
    s_barrier
    s_cmp_ge_u32 s3, 12
    s_cbranch_scc1 YCD_39
    s_add_u32 s10, s67, 50176
    s_add_u32 s11, s66, 147456
    s_mov_b32 m0, s10
    s_add_u32 s10, s10, 12544
    buffer_load_dwordx4 v15, s[48:51], s11 offen nt lds
    s_add_u32 s11, s11, 12288
    s_mov_b32 m0, s10
    s_add_u32 s10, s10, 12544
    buffer_load_dwordx4 v15, s[48:51], s11 offen nt lds
    s_add_u32 s11, s11, 12288
YCD_39:
    s_cmp_lg_u32 s68, 1
    s_cbranch_scc1 YSR_40
    ds_read_b128 v[40:43], v11 offset:25088
    ds_read_b128 v[44:47], v11 offset:25344
    ds_read_b128 v[48:51], v11 offset:25600
    ds_read_b128 v[52:55], v11 offset:25856
    ds_read_b128 v[56:59], v11 offset:26112
    ds_read_b128 v[60:63], v11 offset:26368
YSR_40:
    ds_read_b64_tr_b16 v[78:79], v8 offset:25088
    ds_read_b64_tr_b16 v[82:83], v8 offset:25216
    ds_read_b64_tr_b16 v[86:87], v8 offset:25344
    s_waitcnt vmcnt(4)
    s_waitcnt lgkmcnt(0)
    s_barrier
    s_cmp_ge_u32 s3, 12
    s_cbranch_scc1 YCD_41
    s_add_u32 s10, s67, 75264
    s_add_u32 s11, s66, 172032
    s_mov_b32 m0, s10
    s_add_u32 s10, s10, 12544
    buffer_load_dwordx4 v15, s[48:51], s11 offen nt lds
    s_add_u32 s11, s11, 12288
    s_mov_b32 m0, s10
    s_add_u32 s10, s10, 12544
    buffer_load_dwordx4 v15, s[48:51], s11 offen nt lds
    s_add_u32 s11, s11, 12288
YCD_41:
    s_cmp_lg_u32 s68, 2
    s_cbranch_scc1 YSR_42
    ds_read_b128 v[16:19], v13 offset:0
    ds_read_b128 v[20:23], v13 offset:256
    ds_read_b128 v[24:27], v13 offset:512
    ds_read_b128 v[28:31], v13 offset:768
    ds_read_b128 v[32:35], v13 offset:1024
    ds_read_b128 v[36:39], v13 offset:1280
YSR_42:
    ds_read_b64_tr_b16 v[88:89], v14 offset:0
    ds_read_b64_tr_b16 v[92:93], v14 offset:128
    ds_read_b64_tr_b16 v[96:97], v14 offset:256
    s_waitcnt vmcnt(4)
    s_waitcnt lgkmcnt(0)
    s_barrier
    s_cmp_lg_u32 s68, 2
    s_cbranch_scc1 YSR_43
    ds_read_b128 v[40:43], v13 offset:25088
    ds_read_b128 v[44:47], v13 offset:25344
    ds_read_b128 v[48:51], v13 offset:25600
    ds_read_b128 v[52:55], v13 offset:25856
    ds_read_b128 v[56:59], v13 offset:26112
    ds_read_b128 v[60:63], v13 offset:26368
YSR_43:
    ds_read_b64_tr_b16 v[90:91], v14 offset:25088
    ds_read_b64_tr_b16 v[94:95], v14 offset:25216
    ds_read_b64_tr_b16 v[98:99], v14 offset:25344
    s_waitcnt vmcnt(2)
    s_waitcnt lgkmcnt(0)
    s_barrier
    s_cmp_lg_u32 s68, 3
    s_cbranch_scc1 YSR_44
    ds_read_b128 v[16:19], v11 offset:0
    ds_read_b128 v[20:23], v11 offset:256
    ds_read_b128 v[24:27], v11 offset:512
    ds_read_b128 v[28:31], v11 offset:768
    ds_read_b128 v[32:35], v11 offset:1024
    ds_read_b128 v[36:39], v11 offset:1280
YSR_44:
    ds_read_b64_tr_b16 v[100:101], v8 offset:0
    ds_read_b64_tr_b16 v[104:105], v8 offset:128
    ds_read_b64_tr_b16 v[108:109], v8 offset:256
    s_waitcnt vmcnt(0)
    s_waitcnt lgkmcnt(0)
    s_barrier
    s_cmp_lg_u32 s68, 3
    s_cbranch_scc1 YSR_45
    ds_read_b128 v[40:43], v11 offset:25088
    ds_read_b128 v[44:47], v11 offset:25344
    ds_read_b128 v[48:51], v11 offset:25600
    ds_read_b128 v[52:55], v11 offset:25856
    ds_read_b128 v[56:59], v11 offset:26112
    ds_read_b128 v[60:63], v11 offset:26368
YSR_45:
    ds_read_b64_tr_b16 v[102:103], v8 offset:25088
    ds_read_b64_tr_b16 v[106:107], v8 offset:25216
    ds_read_b64_tr_b16 v[110:111], v8 offset:25344
    s_waitcnt lgkmcnt(0)
    s_mul_i32 s6, s6, 1664525
    s_add_u32 s6, s6, 1013904223
    v_mov_b32 v4, s6
    s_cmp_lg_u32 s3, 15
    s_cbranch_scc1 HEL_46
    s_getreg_b32 s9, hwreg(HW_REG_XCC_ID, 0, 4)
    s_lshl_b32 s10, s4, 8
    s_lshr_b32 s11, s2, 3
    s_lshl_b32 s11, s11, 3
    s_add_u32 s10, s10, s11
    s_add_u32 s10, s10, 4096
    v_mov_b32 v120, s9
    v_mov_b32 v121, s6
    v_mov_b32 v122, 0
    s_mov_b64 exec, 1
    buffer_store_dwordx2 v[120:121], v122, s[44:47], s10 offen sc1
    s_mov_b64 exec, -1
HEL_46:
    s_mov_b32 s48, s26
    s_mov_b32 s49, s27
    s_mov_b32 s50, 7864320
    s_mov_b32 s51, 0x00020000
    v_lshrrev_b32 v5, 5, v1
    v_lshlrev_b32 v5, 2, v5
    v_bfe_u32 v12, v1, 1, 2
    v_add_u32 v5, v5, v12
    v_mul_u32_u24 v5, 1280, v5
    v_bfe_u32 v12, v1, 3, 2
    v_lshl_add_u32 v5, v12, 5, v5
    v_and_b32 v12, 1, v1
    v_lshl_add_u32 v0, v12, 4, v5
    s_mul_i32 s67, s4, 768
    s_lshl_b32 s10, s3, 3
    s_add_u32 s67, s67, s10
    s_mul_i32 s67, s67, 1280
    s_lshl_b32 s10, s5, 7
    s_add_u32 s67, s67, s10
    s_lshl_b32 s66, s3, 10
    v_and_b32 v7, 7, v3
    v_mul_u32_u24 v7, 1552, v7
    v_lshl_add_u32 v7, v2, 4, v7
    s_mul_i32 s9, s69, 384
    s_add_u32 s9, s9, 100352
    v_add_u32 v7, s9, v7
    v_mul_u32_u24 v8, 272, v2
    v_lshl_add_u32 v8, v3, 4, v8
    s_lshl_b32 s9, s69, 3
    s_lshl_b32 s10, s68, 1
    s_add_u32 s9, s9, s10
    s_mul_i32 s9, s9, 1088
    s_add_u32 s9, s9, 112768
    v_add_u32 v8, s9, v8
    v_mul_u32_u24 v10, 1088, v2
    v_bfe_u32 v5, v1, 2, 2
    v_mul_u32_u24 v11, 272, v5
    v_and_b32 v12, 3, v1
    v_lshlrev_b32 v13, 2, v12
    v_add3_u32 v10, v10, v11, v13
    s_lshl_b32 s9, s3, 4
    s_add_u32 s10, s9, 112768
    v_add_u32 v10, s10, v10
    v_lshrrev_b32 v11, 5, v1
    v_lshlrev_b32 v11, 10, v11
    v_lshl_add_u32 v11, v5, 8, v11
    v_bfe_u32 v13, v1, 4, 1
    v_lshl_add_u32 v11, v13, 3, v11
    v_lshl_add_u32 v11, v12, 1, v11
    s_add_u32 s10, s9, 147584
    v_add_u32 v11, s10, v11
    v_and_b32 v13, 7, v3
    v_mul_u32_u24 v13, 96, v13
    v_lshl_add_u32 v13, v2, 3, v13
    s_mul_i32 s9, s3, 768
    s_add_u32 s9, s9, 112768
    v_add_u32 v13, s9, v13
    v_lshrrev_b32 v14, 3, v1
    v_mul_u32_u24 v12, 96, v14
    v_and_b32 v5, 7, v1
    v_mul_u32_u24 v15, 12, v5
    v_add3_u32 v12, v12, v15, s9
    v_mul_u32_u24 v14, 69632, v14
    v_lshl_add_u32 v14, v5, 4, v14
    v_lshlrev_b32 v15, 4, v1
    v_add_u32 v15, 147584, v15
    s_mul_i32 s70, s7, 557056
    s_lshl_b32 s10, s4, 2
    s_add_u32 s10, s10, s8
    s_mul_i32 s11, s10, 2176
    s_add_u32 s70, s70, s11
    s_add_u32 s71, s70, 2099200
    s_lshl_b32 s11, s3, 7
    s_add_u32 s70, s70, s11
    s_add_u32 s70, s70, 2097152
    s_cmp_ge_u32 s5, 10
    s_cbranch_scc1 YWO_47
    s_mov_b32 m0, s66
    s_add_u32 s66, s66, 16384
    buffer_load_dwordx4 v0, s[48:51], s67 offen nt lds
    s_add_u32 s67, s67, 163840
YWO_47:
    s_lshl_b32 s9, s7, 14
    s_lshl_b32 s10, s3, 10
    s_add_u32 s9, s9, s10
    s_add_u32 s9, s9, 262144
    s_mov_b32 s13, 0
    s_mov_b64 s[100:101], exec
    s_mov_b64 s[84:85], exec
POLL_48:
    s_mov_b64 exec, s[84:85]
    buffer_load_dwordx4 v[112:115], v6, s[44:47], s9 offen sc1
    s_waitcnt vmcnt(0)
    s_mov_b64 exec, s[84:85]
    v_bitop3_b32 v120, v112, v113, v114 bitop3:0x96
    v_bitop3_b32 v120, v120, v115, v4 bitop3:0x96
    v_cmp_ne_u32 vcc, 0, v120
    s_mov_b64 s[84:85], vcc
    s_mov_b64 s[14:15], vcc
    s_mov_b64 exec, s[100:101]
    s_add_u32 s13, s13, 1
    s_cmp_eq_u64 s[14:15], 0
    s_cbranch_scc1 PDONE_49
    s_cmp_lt_u32 s13, 65536
    s_cbranch_scc1 POLL_48
    s_mov_b64 exec, s[100:101]
PDONE_49:
    ds_write2_b32 v9, v112, v113 offset1:1
    ds_write_b32 v9, v114 offset:8
Y_E2D:
    s_waitcnt lgkmcnt(0)
    s_barrier
    s_cmp_ge_u32 s5, 10
    s_cbranch_scc1 YWO_51
    s_mov_b32 m0, s66
    s_add_u32 s66, s66, 16384
    buffer_load_dwordx4 v0, s[48:51], s67 offen nt lds
    s_add_u32 s67, s67, 163840
YWO_51:
    ds_read_b128 v[112:115], v7 offset:0
    ds_read_b128 v[116:119], v7 offset:64
    s_waitcnt lgkmcnt(1)
    v_mfma_f32_16x16x32_bf16 v[120:123], v[16:19], v[112:115], 0
    v_mfma_f32_16x16x32_bf16 v[124:127], v[40:43], v[112:115], 0
    ds_read_b128 v[112:115], v7 offset:128
    s_waitcnt lgkmcnt(1)
    v_mfma_f32_16x16x32_bf16 v[120:123], v[20:23], v[116:119], v[120:123]
    v_mfma_f32_16x16x32_bf16 v[124:127], v[44:47], v[116:119], v[124:127]
    ds_read_b128 v[116:119], v7 offset:192
    s_waitcnt lgkmcnt(1)
    v_mfma_f32_16x16x32_bf16 v[120:123], v[24:27], v[112:115], v[120:123]
    v_mfma_f32_16x16x32_bf16 v[124:127], v[48:51], v[112:115], v[124:127]
    ds_read_b128 v[112:115], v7 offset:256
    s_waitcnt lgkmcnt(1)
    v_mfma_f32_16x16x32_bf16 v[120:123], v[28:31], v[116:119], v[120:123]
    v_mfma_f32_16x16x32_bf16 v[124:127], v[52:55], v[116:119], v[124:127]
    ds_read_b128 v[116:119], v7 offset:320
    s_waitcnt lgkmcnt(1)
    v_mfma_f32_16x16x32_bf16 v[120:123], v[32:35], v[112:115], v[120:123]
    v_mfma_f32_16x16x32_bf16 v[124:127], v[56:59], v[112:115], v[124:127]
    s_waitcnt lgkmcnt(0)
    v_mfma_f32_16x16x32_bf16 v[120:123], v[36:39], v[116:119], v[120:123]
    v_mfma_f32_16x16x32_bf16 v[124:127], v[60:63], v[116:119], v[124:127]
    s_nop 7
    ds_write_b128 v8, v[120:123]
    ds_write_b128 v8, v[124:127] offset:1088
    s_waitcnt lgkmcnt(0)
    s_barrier
    s_cmp_ge_u32 s5, 10
    s_cbranch_scc1 YWH_52
    s_cmp_lt_u32 s3, 8
    s_cbranch_scc1 YWL_53
    s_mov_b32 m0, s66
    s_sub_u32 s9, s66, 8192
    s_sub_u32 s10, s67, 81920
    buffer_load_dwordx4 v0, s[48:51], s67 offen nt lds
    s_mov_b32 m0, s9
    s_nop 0
    buffer_load_dwordx4 v0, s[48:51], s10 offen nt lds
YWL_53:
    s_add_u32 s66, s66, 16384
    s_add_u32 s67, s67, 163840
YWH_52:
    s_cmp_ge_u32 s3, 8
    s_cbranch_scc1 Y_SMD
    ds_read_b32 v112, v10 offset:0
    ds_read_b32 v116, v10 offset:4352
    ds_read_b32 v113, v10 offset:8704
    ds_read_b32 v117, v10 offset:13056
    ds_read_b32 v114, v10 offset:17408
    ds_read_b32 v118, v10 offset:21760
    ds_read_b32 v115, v10 offset:26112
    ds_read_b32 v119, v10 offset:30464
    s_lshl_b32 s9, s3, 2
    s_add_u32 s9, s9, 151680
    v_mov_b32 v5, s9
    s_waitcnt lgkmcnt(0)
    v_add_f32 v112, v112, v113
    v_add_f32 v114, v114, v115
    v_add_f32 v116, v116, v117
    v_add_f32 v118, v118, v119
    v_add_f32 v112, v112, v114
    v_add_f32 v114, v116, v118
    v_max_f32 v116, v112, v114
    s_nop 1
    s_nop 1
    v_max_f32_dpp v116, v116, v116 row_ror:8 row_mask:0xf bank_mask:0xf
    s_nop 1
    v_max_f32_dpp v116, v116, v116 row_ror:4 row_mask:0xf bank_mask:0xf
    s_nop 1
    v_max_f32_dpp v116, v116, v116 row_ror:2 row_mask:0xf bank_mask:0xf
    s_nop 1
    v_max_f32_dpp v116, v116, v116 row_ror:1 row_mask:0xf bank_mask:0xf
    s_nop 1
    v_mov_b32 v117, v116
    s_nop 1
    v_permlane16_swap_b32 v116, v117
    s_nop 1
    v_max_f32 v116, v116, v117
    v_mov_b32 v117, v116
    s_nop 1
    v_permlane32_swap_b32 v116, v117
    s_nop 1
    v_max_f32 v116, v116, v117
    v_sub_f32 v112, v112, v116
    v_sub_f32 v114, v114, v116
    v_exp_f32 v112, v112
    v_exp_f32 v114, v114
    s_nop 0
    v_cvt_pk_bf16_f32 v112, v112, v114
    ds_write_b16 v11, v112
    ds_write_b16_d16_hi v11, v112 offset:2048
    s_mov_b64 exec, 1
    ds_write_b32 v5, v116
    s_mov_b64 exec, -1
Y_SMD:
    s_waitcnt lgkmcnt(0)
    s_barrier
    ds_read_b128 v[112:115], v15 offset:0
    ds_read_b128 v[116:119], v15 offset:1024
    ds_read_b128 v[120:123], v15 offset:2048
    ds_read_b128 v[124:127], v15 offset:3072
    s_cmp_lg_u32 s69, 0
    s_cbranch_scc1 PR_54
    s_setprio 3
PR_54:
    s_cmp_lg_u32 s69, 1
    s_cbranch_scc1 PR_55
    s_setprio 2
PR_55:
    s_cmp_lg_u32 s69, 2
    s_cbranch_scc1 PR_56
    s_setprio 1
PR_56:
    s_waitcnt lgkmcnt(3)
    v_mfma_f32_16x16x32_bf16 v[16:19], v[64:67], v[112:115], 0
    v_mfma_f32_16x16x32_bf16 v[20:23], v[68:71], v[112:115], 0
    v_mfma_f32_16x16x32_bf16 v[24:27], v[72:75], v[112:115], 0
    s_waitcnt lgkmcnt(2)
    v_mfma_f32_16x16x32_bf16 v[16:19], v[76:79], v[116:119], v[16:19]
    v_mfma_f32_16x16x32_bf16 v[20:23], v[80:83], v[116:119], v[20:23]
    v_mfma_f32_16x16x32_bf16 v[24:27], v[84:87], v[116:119], v[24:27]
    s_waitcnt lgkmcnt(1)
    v_mfma_f32_16x16x32_bf16 v[16:19], v[88:91], v[120:123], v[16:19]
    v_mfma_f32_16x16x32_bf16 v[20:23], v[92:95], v[120:123], v[20:23]
    v_mfma_f32_16x16x32_bf16 v[24:27], v[96:99], v[120:123], v[24:27]
    s_waitcnt lgkmcnt(0)
    v_mfma_f32_16x16x32_bf16 v[16:19], v[100:103], v[124:127], v[16:19]
    v_mfma_f32_16x16x32_bf16 v[20:23], v[104:107], v[124:127], v[20:23]
    v_mfma_f32_16x16x32_bf16 v[24:27], v[108:111], v[124:127], v[24:27]
    s_cmp_lg_u32 s3, 15
    s_cbranch_scc1 Y_NL
    v_mov_b32 v32, 0x3f803f80
    v_mov_b32 v33, 0x3f803f80
    v_mov_b32 v34, 0x3f803f80
    v_mov_b32 v35, 0x3f803f80
    v_and_b32 v41, 7, v3
    v_lshlrev_b32 v41, 2, v41
    v_add_u32 v41, 151680, v41
    ds_read_b32 v40, v41
    v_mfma_f32_16x16x32_bf16 v[36:39], v[32:35], v[112:115], 0
    v_mfma_f32_16x16x32_bf16 v[36:39], v[32:35], v[116:119], v[36:39]
    v_mfma_f32_16x16x32_bf16 v[36:39], v[32:35], v[120:123], v[36:39]
    v_mfma_f32_16x16x32_bf16 v[36:39], v[32:35], v[124:127], v[36:39]
Y_NL:
    s_nop 7
    v_cvt_pk_bf16_f32 v44, v16, v17
    v_cvt_pk_bf16_f32 v45, v18, v19
    v_cvt_pk_bf16_f32 v46, v20, v21
    v_cvt_pk_bf16_f32 v47, v22, v23
    v_cvt_pk_bf16_f32 v48, v24, v25
    v_cvt_pk_bf16_f32 v49, v26, v27
    s_mov_b32 exec_lo, 0xff00ff
    s_mov_b32 exec_hi, 0xff00ff
    ds_write_b64 v13, v[44:45] offset:0
    ds_write_b64 v13, v[46:47] offset:32
    ds_write_b64 v13, v[48:49] offset:64
    s_mov_b64 exec, -1
    s_waitcnt lgkmcnt(0)
    ds_read2_b32 v[52:53], v12 offset1:1
    ds_read_b32 v54, v12 offset:8
    s_waitcnt lgkmcnt(0)
    v_bitop3_b32 v55, v52, v53, v54 bitop3:0x96
    v_xor_b32 v55, v4, v55
    buffer_store_dwordx4 v[52:55], v14, s[44:47], s70 offen sc1
    s_cmp_lg_u32 s3, 15
    s_cbranch_scc1 Y_P3D
    s_mov_b32 s9, 69632
    v_mul_lo_u32 v5, v3, s9
    s_mov_b32 s9, s71
    s_waitcnt lgkmcnt(0)
    v_mov_b32 v56, v40
    v_mov_b32 v57, v36
    v_mov_b32 v58, 0
    v_bitop3_b32 v59, v56, v57, v4 bitop3:0x96
    s_mov_b64 exec, 0xff
    buffer_store_dwordx4 v[56:59], v5, s[44:47], s9 offen sc1
    s_mov_b64 exec, -1
Y_P3D:
    s_cmp_ge_u32 s5, 10
    s_cbranch_scc1 Y_MLP
    s_waitcnt vmcnt(0)
    s_cmp_ge_u32 s5, 10
    s_cbranch_scc1 YWO_57
    s_mov_b32 m0, s66
    s_add_u32 s66, s66, 16384
    buffer_load_dwordx4 v0, s[48:51], s67 offen nt lds
    s_add_u32 s67, s67, 163840
YWO_57:
    s_cmp_ge_u32 s5, 10
    s_cbranch_scc1 YWO_58
    s_mov_b32 m0, s66
    s_add_u32 s66, s66, 16384
    buffer_load_dwordx4 v0, s[48:51], s67 offen nt lds
    s_add_u32 s67, s67, 163840
YWO_58:
    s_cmp_ge_u32 s5, 10
    s_cbranch_scc1 YWO_59
    s_mov_b32 m0, s66
    s_add_u32 s66, s66, 16384
    buffer_load_dwordx4 v0, s[48:51], s67 offen nt lds
    s_add_u32 s67, s67, 163840
YWO_59:
    s_waitcnt vmcnt(0)
    s_waitcnt lgkmcnt(0)
    s_barrier
    s_cmp_ge_u32 s3, 12
    s_cbranch_scc1 Y_B5
    v_lshlrev_b32 v5, 10, v2
    v_lshl_add_u32 v5, v3, 3, v5
    s_lshl_b32 s9, s3, 13
    v_add_u32 v5, s9, v5
    ds_read_b64_tr_b16 v[64:65], v5 offset:0
    ds_read_b64_tr_b16 v[66:67], v5 offset:512
    ds_read_b64_tr_b16 v[68:69], v5 offset:128
    ds_read_b64_tr_b16 v[70:71], v5 offset:640
    ds_read_b64_tr_b16 v[72:73], v5 offset:256
    ds_read_b64_tr_b16 v[74:75], v5 offset:768
    ds_read_b64_tr_b16 v[76:77], v5 offset:384
    ds_read_b64_tr_b16 v[78:79], v5 offset:896
    s_waitcnt lgkmcnt(0)
    ds_read_b64_tr_b16 v[80:81], v5 offset:4096
    ds_read_b64_tr_b16 v[82:83], v5 offset:4608
    ds_read_b64_tr_b16 v[84:85], v5 offset:4224
    ds_read_b64_tr_b16 v[86:87], v5 offset:4736
    ds_read_b64_tr_b16 v[88:89], v5 offset:4352
    ds_read_b64_tr_b16 v[90:91], v5 offset:4864
    ds_read_b64_tr_b16 v[92:93], v5 offset:4480
    ds_read_b64_tr_b16 v[94:95], v5 offset:4992
    v_lshlrev_b32 v5, 4, v1
    s_mul_i32 s9, s4, 12288
    s_lshl_b32 s10, s3, 10
    s_add_u32 s9, s9, s10
    s_add_u32 s9, s9, 458752
    s_mul_i32 s10, s64, 1552
    s_lshl_b32 s11, s65, 9
    s_add_u32 s10, s10, s11
    s_add_u32 s10, s10, 100352
    v_lshl_add_u32 v6, v1, 3, s10
    v_and_b32 v7, 3, v1
    v_mul_u32_u24 v7, 1552, v7
    v_lshl_add_u32 v7, v2, 4, v7
    s_lshl_b32 s10, s3, 7
    s_add_u32 s10, s10, 100352
    v_add_u32 v7, s10, v7
    v_lshlrev_b32 v9, 2, v1
    v_add_u32 v9, 151744, v9
    s_lshl_b32 s10, s3, 8
    v_add_u32 v8, s10, v9
    v_cmp_eq_u32 s[66:67], 1, v2
    v_cmp_eq_u32 s[68:69], 2, v2
    v_cmp_eq_u32 s[42:43], 3, v2
    s_mov_b32 s13, 0
    s_mov_b64 s[100:101], exec
    s_mov_b64 s[84:85], exec
POLL_60:
    s_mov_b64 exec, s[84:85]
    buffer_load_dwordx4 v[96:99], v5, s[44:47], s9 offen sc1
    s_waitcnt vmcnt(0)
    s_mov_b64 exec, s[84:85]
    v_xor_b32 v112, s6, v97
    v_xor_b32 v113, s6, v99
    v_or_b32 v112, v112, v113
    v_cmp_ne_u32 vcc, 0, v112
    s_mov_b64 s[84:85], vcc
    s_mov_b64 s[14:15], vcc
    s_mov_b64 exec, s[100:101]
    s_add_u32 s13, s13, 1
    s_cmp_eq_u64 s[14:15], 0
    s_cbranch_scc1 PDONE_61
    s_cmp_lt_u32 s13, 65536
    s_cbranch_scc1 POLL_60
    s_mov_b64 exec, s[100:101]
PDONE_61:
    v_mov_b32 v97, v98
    ds_write_b64 v6, v[96:97]
Y_B5:
    s_waitcnt lgkmcnt(0)
    s_barrier
    s_cmp_ge_u32 s3, 12
    s_cbranch_scc1 Y_B6
    ds_read_b128 v[96:99], v7
    ds_read_b128 v[104:107], v7 offset:64
    s_waitcnt lgkmcnt(1)
    v_mfma_f32_16x16x32_bf16 v[16:19], v[96:99], v[64:67], 0
    v_mfma_f32_16x16x32_bf16 v[20:23], v[96:99], v[68:71], 0
    v_mfma_f32_16x16x32_bf16 v[24:27], v[96:99], v[72:75], 0
    v_mfma_f32_16x16x32_bf16 v[28:31], v[96:99], v[76:79], 0
    s_waitcnt lgkmcnt(0)
    v_mfma_f32_16x16x32_bf16 v[16:19], v[104:107], v[80:83], v[16:19]
    v_mfma_f32_16x16x32_bf16 v[20:23], v[104:107], v[84:87], v[20:23]
    v_mfma_f32_16x16x32_bf16 v[24:27], v[104:107], v[88:91], v[24:27]
    v_mfma_f32_16x16x32_bf16 v[28:31], v[104:107], v[92:95], v[28:31]
    s_nop 4
    v_add_f32 v16, v16, v17
    v_add_f32 v18, v18, v19
    v_add_f32 v20, v20, v21
    v_add_f32 v22, v22, v23
    v_add_f32 v24, v24, v25
    v_add_f32 v26, v26, v27
    v_add_f32 v28, v28, v29
    v_add_f32 v30, v30, v31
    v_add_f32 v16, v16, v18
    v_add_f32 v20, v20, v22
    v_add_f32 v24, v24, v26
    v_add_f32 v28, v28, v30
    v_cndmask_b32 v16, v16, v20, s[66:67]
    v_cndmask_b32 v16, v16, v24, s[68:69]
    v_cndmask_b32 v16, v16, v28, s[42:43]
    ds_write_b32 v8, v16
Y_B6:
    s_waitcnt lgkmcnt(0)
    s_barrier
    s_cmp_lg_u32 s3, 0
    s_cbranch_scc1 Y_END
    ds_read2st64_b32 v[16:17], v9 offset0:0 offset1:1
    ds_read2st64_b32 v[18:19], v9 offset0:2 offset1:3
    ds_read2st64_b32 v[20:21], v9 offset0:4 offset1:5
    ds_read2st64_b32 v[22:23], v9 offset0:6 offset1:7
    ds_read2st64_b32 v[24:25], v9 offset0:8 offset1:9
    ds_read2st64_b32 v[26:27], v9 offset0:10 offset1:11
    s_mul_i32 s9, s4, 2560
    s_lshl_b32 s10, s5, 8
    s_add_u32 s9, s9, s10
    s_add_u32 s9, s9, 589824
    v_lshlrev_b32 v5, 2, v1
    s_waitcnt lgkmcnt(0)
    v_add_f32 v16, v16, v17
    v_add_f32 v18, v18, v19
    v_add_f32 v20, v20, v21
    v_add_f32 v22, v22, v23
    v_add_f32 v24, v24, v25
    v_add_f32 v26, v26, v27
    v_add_f32 v16, v16, v18
    v_add_f32 v20, v20, v22
    v_add_f32 v24, v24, v26
    v_add_f32 v16, v16, v20
    v_add_f32 v16, v16, v24
    s_nop 1
    v_mov_b32_dpp v17, v16 quad_perm:[1,1,3,3] row_mask:0xf bank_mask:0xf
    v_cvt_pk_bf16_f32 v16, v16, v17
    v_mov_b32 v17, v4
    s_mov_b32 exec_lo, 0x55555555
    s_mov_b32 exec_hi, 0x55555555
    buffer_store_dwordx2 v[16:17], v5, s[44:47], s9 offen sc1
    s_mov_b64 exec, -1
    s_branch Y_END
Y_MLP:
    s_mul_i32 s66, s4, 6
    s_add_u32 s66, s66, s5
    s_sub_u32 s66, s66, 10
    s_mov_b32 s48, s30
    s_mov_b32 s49, s31
    s_mov_b32 s50, 1966080
    s_mov_b32 s51, 0x00020000
    s_mov_b32 s52, s32
    s_mov_b32 s53, s33
    s_mov_b32 s54, 1966080
    s_mov_b32 s55, 0x00020000
    s_mov_b32 s56, s34
    s_mov_b32 s57, s35
    s_mov_b32 s58, 1966080
    s_mov_b32 s59, 0x00020000
    s_mov_b32 s60, s16
    s_mov_b32 s61, s17
    s_mov_b32 s62, 1280
    s_mov_b32 s63, 0x00020000
    v_lshrrev_b32 v5, 4, v1
    v_lshlrev_b32 v5, 2, v5
    v_bfe_u32 v6, v1, 1, 2
    v_add_u32 v5, v5, v6
    v_mul_u32_u24 v5, 3072, v5
    v_bfe_u32 v6, v1, 3, 1
    v_lshl_add_u32 v5, v6, 5, v5
    v_and_b32 v6, 1, v1
    v_lshl_add_u32 v15, v6, 4, v5
    v_bfe_u32 v5, v1, 1, 2
    v_mul_u32_u24 v5, 1280, v5
    v_lshrrev_b32 v6, 3, v1
    v_lshl_add_u32 v5, v6, 5, v5
    v_and_b32 v6, 1, v1
    v_lshl_add_u32 v14, v6, 4, v5
    s_waitcnt lgkmcnt(0)
    s_barrier
    s_and_b32 s9, s3, 7
    s_mul_i32 s11, s9, 245760
    s_lshl_b32 s10, s66, 6
    s_add_u32 s11, s11, s10
    s_mul_i32 s10, s9, 5120
    s_cmp_ge_u32 s3, 8
    s_cbranch_scc1 Y_MU
    s_mov_b32 s12, 5
DMA_63:
    s_mov_b32 m0, s10
    s_add_u32 s10, s10, 1024
    buffer_load_dwordx4 v15, s[48:51], s11 offen nt lds
    s_add_u32 s11, s11, 49152
    s_sub_u32 s12, s12, 1
    s_cmp_lg_u32 s12, 0
    s_cbranch_scc1 DMA_63
    s_lshl_b32 s11, s66, 5
    s_lshl_b32 s10, s3, 2
    s_add_u32 s11, s11, s10
    s_mul_i32 s11, s11, 1280
    s_mul_i32 s10, s3, 5120
    s_add_u32 s10, s10, 81920
    s_mov_b32 s12, 5
DMA_64:
    s_mov_b32 m0, s10
    s_add_u32 s10, s10, 1024
    buffer_load_dwordx4 v14, s[56:59], s11 offen nt lds
    s_add_u32 s11, s11, 256
    s_sub_u32 s12, s12, 1
    s_cmp_lg_u32 s12, 0
    s_cbranch_scc1 DMA_64
    s_branch Y_MW
Y_MU:
    s_add_u32 s10, s10, 40960
    s_mov_b32 s12, 5
DMA_65:
    s_mov_b32 m0, s10
    s_add_u32 s10, s10, 1024
    buffer_load_dwordx4 v15, s[52:55], s11 offen nt lds
    s_add_u32 s11, s11, 49152
    s_sub_u32 s12, s12, 1
    s_cmp_lg_u32 s12, 0
    s_cbranch_scc1 DMA_65
Y_MW:
    v_and_b32 v5, 31, v1
    v_lshlrev_b32 v5, 3, v5
    s_lshl_b32 s9, s3, 8
    s_cmp_ge_u32 s3, 5
    s_cbranch_scc1 Y_NX
    buffer_load_dwordx2 v[110:111], v5, s[60:63], s9 offen
Y_NX:
    s_waitcnt vmcnt(0)
    s_waitcnt lgkmcnt(0)
    s_barrier
    s_cmp_ge_u32 s3, 10
    s_cbranch_scc1 Y_MPD
    v_lshlrev_b32 v5, 9, v2
    v_lshl_add_u32 v5, v3, 3, v5
    s_lshl_b32 s9, s3, 12
    v_add_u32 v5, s9, v5
    ds_read_b64_tr_b16 v[16:17], v5 offset:0
    ds_read_b64_tr_b16 v[18:19], v5 offset:256
    ds_read_b64_tr_b16 v[20:21], v5 offset:128
    ds_read_b64_tr_b16 v[22:23], v5 offset:384
    ds_read_b64_tr_b16 v[24:25], v5 offset:2048
    ds_read_b64_tr_b16 v[26:27], v5 offset:2304
    ds_read_b64_tr_b16 v[28:29], v5 offset:2176
    ds_read_b64_tr_b16 v[30:31], v5 offset:2432
    s_waitcnt lgkmcnt(0)
    ds_read_b64_tr_b16 v[32:33], v5 offset:40960
    ds_read_b64_tr_b16 v[34:35], v5 offset:41216
    ds_read_b64_tr_b16 v[36:37], v5 offset:41088
    ds_read_b64_tr_b16 v[38:39], v5 offset:41344
    ds_read_b64_tr_b16 v[40:41], v5 offset:43008
    ds_read_b64_tr_b16 v[42:43], v5 offset:43264
    ds_read_b64_tr_b16 v[44:45], v5 offset:43136
    ds_read_b64_tr_b16 v[46:47], v5 offset:43392
    s_waitcnt lgkmcnt(0)
    v_mul_u32_u24 v5, 10240, v2
    v_lshl_add_u32 v5, v3, 3, v5
    s_lshl_b32 s9, s3, 9
    s_add_u32 s9, s9, 81920
    v_add_u32 v5, s9, v5
    ds_read_b64_tr_b16 v[48:49], v5 offset:0
    ds_read_b64_tr_b16 v[50:51], v5 offset:5120
    ds_read_b64_tr_b16 v[52:53], v5 offset:128
    ds_read_b64_tr_b16 v[54:55], v5 offset:5248
    ds_read_b64_tr_b16 v[56:57], v5 offset:256
    ds_read_b64_tr_b16 v[58:59], v5 offset:5376
    ds_read_b64_tr_b16 v[60:61], v5 offset:384
    ds_read_b64_tr_b16 v[62:63], v5 offset:5504
Y_MPD:
    v_lshlrev_b32 v9, 2, v1
    v_add_u32 v9, 133760, v9
    s_lshl_b32 s9, s3, 8
    v_add_u32 v8, s9, v9
    v_and_b32 v12, 31, v1
    s_lshl_b32 s9, s3, 6
    s_add_u32 s9, s9, 136448
    v_lshl_add_u32 v10, v12, 1, s9
    v_lshl_add_u32 v11, v2, 4, s9
    v_lshlrev_b32 v12, 3, v1
    v_mov_b32 v13, 133632
    v_lshlrev_b32 v14, 5, v2
    s_lshl_b32 s9, s3, 8
    s_add_u32 s9, s9, 131072
    v_add_u32 v14, s9, v14
    s_mul_i32 s65, s66, 5120
    s_lshl_b32 s10, s3, 9
    s_add_u32 s65, s65, s10
    s_add_u32 s65, s65, 1048576
    v_cmp_eq_u32 s[66:67], 1, v2
    v_cmp_eq_u32 s[68:69], 2, v2
    v_cmp_eq_u32 s[42:43], 3, v2
    s_cmp_ge_u32 s3, 5
    s_cbranch_scc1 Y_MB6
    v_and_b32 v6, 31, v1
    v_lshrrev_b32 v5, 5, v1
    v_mul_u32_u24 v5, 10240, v5
    v_lshl_add_u32 v5, v6, 4, v5
    s_lshl_b32 s9, s3, 9
    s_add_u32 s9, s9, 589824
    s_add_u32 s10, s9, 5120
    s_mov_b32 s13, 0
    s_mov_b64 s[100:101], exec
    s_mov_b64 s[84:85], exec
    s_mov_b64 s[86:87], exec
    s_mov_b64 s[88:89], exec
    s_mov_b64 s[90:91], exec
POLL_66:
    s_mov_b64 exec, s[84:85]
    s_cbranch_execz PSK_68
    buffer_load_dwordx4 v[80:83], v5, s[44:47], s9 offen offset:0 sc1
PSK_68:
    s_mov_b64 exec, s[86:87]
    s_cbranch_execz PSK_69
    buffer_load_dwordx4 v[84:87], v5, s[44:47], s9 offen offset:2560 sc1
PSK_69:
    s_mov_b64 exec, s[88:89]
    s_cbranch_execz PSK_70
    buffer_load_dwordx4 v[88:91], v5, s[44:47], s10 offen offset:0 sc1
PSK_70:
    s_mov_b64 exec, s[90:91]
    s_cbranch_execz PSK_71
    buffer_load_dwordx4 v[92:95], v5, s[44:47], s10 offen offset:2560 sc1
PSK_71:
    s_waitcnt vmcnt(0)
    s_mov_b64 exec, s[84:85]
    v_xor_b32 v96, s6, v81
    v_xor_b32 v97, s6, v83
    v_or_b32 v96, v96, v97
    v_cmp_ne_u32 vcc, 0, v96
    s_mov_b64 s[84:85], vcc
    s_mov_b64 s[14:15], vcc
    s_mov_b64 exec, s[86:87]
    v_xor_b32 v96, s6, v85
    v_xor_b32 v97, s6, v87
    v_or_b32 v96, v96, v97
    v_cmp_ne_u32 vcc, 0, v96
    s_mov_b64 s[86:87], vcc
    s_or_b64 s[14:15], s[14:15], vcc
    s_mov_b64 exec, s[88:89]
    v_xor_b32 v96, s6, v89
    v_xor_b32 v97, s6, v91
    v_or_b32 v96, v96, v97
    v_cmp_ne_u32 vcc, 0, v96
    s_mov_b64 s[88:89], vcc
    s_or_b64 s[14:15], s[14:15], vcc
    s_mov_b64 exec, s[90:91]
    v_xor_b32 v96, s6, v93
    v_xor_b32 v97, s6, v95
    v_or_b32 v96, v96, v97
    v_cmp_ne_u32 vcc, 0, v96
    s_mov_b64 s[90:91], vcc
    s_or_b64 s[14:15], s[14:15], vcc
    s_mov_b64 exec, s[100:101]
    s_add_u32 s13, s13, 1
    s_cmp_eq_u64 s[14:15], 0
    s_cbranch_scc1 PDONE_67
    s_cmp_lt_u32 s13, 65536
    s_cbranch_scc1 POLL_66
    s_mov_b64 exec, s[100:101]
PDONE_67:
    v_lshlrev_b32 v100, 16, v80
    v_and_b32 v101, 0xffff0000, v80
    v_lshlrev_b32 v102, 16, v82
    v_and_b32 v103, 0xffff0000, v82
    v_lshlrev_b32 v104, 16, v84
    v_and_b32 v105, 0xffff0000, v84
    v_lshlrev_b32 v106, 16, v86
    v_and_b32 v107, 0xffff0000, v86
    v_add_f32 v100, v100, v104
    v_add_f32 v101, v101, v105
    v_add_f32 v102, v102, v106
    v_add_f32 v103, v103, v107
    v_lshlrev_b32 v104, 16, v88
    v_and_b32 v105, 0xffff0000, v88
    v_lshlrev_b32 v106, 16, v90
    v_and_b32 v107, 0xffff0000, v90
    v_add_f32 v100, v100, v104
    v_add_f32 v101, v101, v105
    v_add_f32 v102, v102, v106
    v_add_f32 v103, v103, v107
    v_lshlrev_b32 v104, 16, v92
    v_and_b32 v105, 0xffff0000, v92
    v_lshlrev_b32 v106, 16, v94
    v_and_b32 v107, 0xffff0000, v94
    v_add_f32 v100, v100, v104
    v_add_f32 v101, v101, v105
    v_add_f32 v102, v102, v106
    v_add_f32 v103, v103, v107
    v_mov_b32 v104, v100
    v_mov_b32 v105, v101
    v_mov_b32 v106, v102
    v_mov_b32 v107, v103
    s_nop 1
    v_permlane32_swap_b32 v100, v104
    v_permlane32_swap_b32 v101, v105
    v_permlane32_swap_b32 v102, v106
    v_permlane32_swap_b32 v103, v107
    v_lshlrev_b32 v80, 16, v110
    v_and_b32 v81, 0xffff0000, v110
    v_lshlrev_b32 v82, 16, v111
    v_and_b32 v83, 0xffff0000, v111
    v_add_f32 v100, v100, v104
    v_add_f32 v101, v101, v105
    v_add_f32 v102, v102, v106
    v_add_f32 v103, v103, v107
    v_add_f32 v100, v100, v80
    v_add_f32 v101, v101, v81
    v_add_f32 v102, v102, v82
    v_add_f32 v103, v103, v83
    v_lshlrev_b32 v5, 4, v6
    s_lshl_b32 s9, s3, 9
    s_add_u32 s9, s9, 131072
    v_add_u32 v5, s9, v5
    s_mov_b32 exec_lo, 0xffffffff
    s_mov_b32 exec_hi, 0x0
    ds_write_b128 v5, v[100:103]
    s_mov_b64 exec, -1
    v_add_f32 v104, v100, v101
    v_add_f32 v106, v102, v103
    v_mul_f32 v105, v100, v100
    v_add_f32 v104, v104, v106
    v_fmac_f32 v105, v101, v101
    v_fmac_f32 v105, v102, v102
    v_fmac_f32 v105, v103, v103
    s_nop 1
    s_nop 1
    v_add_f32_dpp v104, v104, v104 row_ror:8 row_mask:0xf bank_mask:0xf
    v_add_f32_dpp v105, v105, v105 row_ror:8 row_mask:0xf bank_mask:0xf
    s_nop 1
    v_add_f32_dpp v104, v104, v104 row_ror:4 row_mask:0xf bank_mask:0xf
    v_add_f32_dpp v105, v105, v105 row_ror:4 row_mask:0xf bank_mask:0xf
    s_nop 1
    v_add_f32_dpp v104, v104, v104 row_ror:2 row_mask:0xf bank_mask:0xf
    v_add_f32_dpp v105, v105, v105 row_ror:2 row_mask:0xf bank_mask:0xf
    s_nop 1
    v_add_f32_dpp v104, v104, v104 row_ror:1 row_mask:0xf bank_mask:0xf
    v_add_f32_dpp v105, v105, v105 row_ror:1 row_mask:0xf bank_mask:0xf
    s_nop 1
    v_mov_b32 v106, v104
    s_nop 1
    v_permlane16_swap_b32 v104, v106
    s_nop 1
    v_add_f32 v104, v104, v106
    v_mov_b32 v106, v105
    s_nop 1
    v_permlane16_swap_b32 v105, v106
    s_nop 1
    v_add_f32 v105, v105, v106
    s_lshl_b32 s9, s3, 3
    s_add_u32 s9, s9, 133632
    v_mov_b32 v5, s9
    s_mov_b64 exec, 1
    ds_write_b64 v5, v[104:105]
    s_mov_b64 exec, -1
Y_MB6:
    s_waitcnt lgkmcnt(0)
    s_barrier
    s_cmp_ge_u32 s3, 10
    s_cbranch_scc1 Y_MB7
    ds_read_b128 v[80:83], v13
    ds_read_b128 v[84:87], v13 offset:16
    ds_read_b64 v[88:89], v13 offset:32
    ds_read_b128 v[92:95], v14 offset:0
    ds_read_b128 v[96:99], v14 offset:16
    ds_read_b128 v[100:103], v14 offset:128
    ds_read_b128 v[104:107], v14 offset:144
    s_waitcnt lgkmcnt(4)
    v_add_f32 v80, v80, v82
    v_add_f32 v81, v81, v83
    v_add_f32 v80, v80, v84
    v_add_f32 v81, v81, v85
    v_add_f32 v80, v80, v86
    v_add_f32 v81, v81, v87
    v_add_f32 v80, v80, v88
    v_add_f32 v81, v81, v89
    v_mul_f32 v80, 0x3acccccd, v80
    v_mul_f32 v81, 0x3acccccd, v81
    v_fma_f32 v81, -v80, v80, v81
    v_max_f32 v81, 0, v81
    v_add_f32 v81, 0x3727c5ac, v81
    v_rsq_f32 v81, v81
    s_nop 0
    v_mul_f32 v80, v80, v81
    s_waitcnt lgkmcnt(0)
    v_fma_f32 v92, v92, v81, -v80
    v_fma_f32 v93, v93, v81, -v80
    v_fma_f32 v94, v94, v81, -v80
    v_fma_f32 v95, v95, v81, -v80
    v_fma_f32 v96, v96, v81, -v80
    v_fma_f32 v97, v97, v81, -v80
    v_fma_f32 v98, v98, v81, -v80
    v_fma_f32 v99, v99, v81, -v80
    v_fma_f32 v100, v100, v81, -v80
    v_fma_f32 v101, v101, v81, -v80
    v_fma_f32 v102, v102, v81, -v80
    v_fma_f32 v103, v103, v81, -v80
    v_fma_f32 v104, v104, v81, -v80
    v_fma_f32 v105, v105, v81, -v80
    v_fma_f32 v106, v106, v81, -v80
    v_fma_f32 v107, v107, v81, -v80
    v_cvt_pk_bf16_f32 v108, v92, v93
    v_cvt_pk_bf16_f32 v109, v94, v95
    v_cvt_pk_bf16_f32 v110, v96, v97
    v_cvt_pk_bf16_f32 v111, v98, v99
    v_cvt_pk_bf16_f32 v112, v100, v101
    v_cvt_pk_bf16_f32 v113, v102, v103
    v_cvt_pk_bf16_f32 v114, v104, v105
    v_cvt_pk_bf16_f32 v115, v106, v107
    s_nop 1
    v_mfma_f32_16x16x32_bf16 v[64:67], v[108:111], v[16:19], 0
    v_mfma_f32_16x16x32_bf16 v[68:71], v[108:111], v[20:23], 0
    v_mfma_f32_16x16x32_bf16 v[72:75], v[108:111], v[32:35], 0
    v_mfma_f32_16x16x32_bf16 v[76:79], v[108:111], v[36:39], 0
    v_mfma_f32_16x16x32_bf16 v[64:67], v[112:115], v[24:27], v[64:67]
    v_mfma_f32_16x16x32_bf16 v[68:71], v[112:115], v[28:31], v[68:71]
    v_mfma_f32_16x16x32_bf16 v[72:75], v[112:115], v[40:43], v[72:75]
    v_mfma_f32_16x16x32_bf16 v[76:79], v[112:115], v[44:47], v[76:79]
    s_nop 5
    v_cndmask_b32 v64, v64, v68, s[66:67]
    v_cndmask_b32 v64, v64, v72, s[68:69]
    v_cndmask_b32 v64, v64, v76, s[42:43]
    ds_write_b32 v8, v64
Y_MB7:
    s_waitcnt lgkmcnt(0)
    s_barrier
    s_cmp_ge_u32 s3, 10
    s_cbranch_scc1 Y_END
    ds_read2st64_b32 v[80:81], v9 offset0:0 offset1:1
    ds_read2st64_b32 v[82:83], v9 offset0:2 offset1:3
    ds_read2st64_b32 v[84:85], v9 offset0:4 offset1:5
    ds_read2st64_b32 v[86:87], v9 offset0:6 offset1:7
    ds_read2st64_b32 v[88:89], v9 offset0:8 offset1:9
    s_waitcnt lgkmcnt(0)
    v_add_f32 v80, v80, v81
    v_add_f32 v82, v82, v83
    v_add_f32 v84, v84, v85
    v_add_f32 v86, v86, v87
    v_add_f32 v88, v88, v89
    v_add_f32 v80, v80, v82
    v_add_f32 v84, v84, v86
    v_add_f32 v80, v80, v88
    v_add_f32 v80, v80, v84
    v_mov_b32 v88, v80
    s_nop 1
    v_permlane32_swap_b32 v80, v88
    s_nop 1
    v_mul_f32 v80, 0xbfb8aa3b, v80
    v_exp_f32 v80, v80
    s_nop 0
    v_add_f32 v80, 1.0, v80
    v_rcp_f32 v80, v80
    s_nop 0
    v_mul_f32 v80, v80, v88
    v_cvt_pk_bf16_f32 v80, v80, v80
    s_mov_b32 exec_lo, 0xffffffff
    s_mov_b32 exec_hi, 0x0
    ds_write_b16 v10, v80
    s_mov_b64 exec, -1
    s_waitcnt lgkmcnt(0)
    ds_read_b128 v[80:83], v11
    s_waitcnt lgkmcnt(0)
    v_mfma_f32_16x16x32_bf16 v[84:87], v[80:83], v[48:51], 0
    v_mfma_f32_16x16x32_bf16 v[88:91], v[80:83], v[52:55], 0
    v_mfma_f32_16x16x32_bf16 v[92:95], v[80:83], v[56:59], 0
    v_mfma_f32_16x16x32_bf16 v[96:99], v[80:83], v[60:63], 0
    s_nop 5
    v_cndmask_b32 v84, v84, v88, s[66:67]
    v_cndmask_b32 v84, v84, v92, s[68:69]
    v_cndmask_b32 v84, v84, v96, s[42:43]
    v_mov_b32 v85, v4
    buffer_store_dwordx2 v[84:85], v12, s[44:47], s65 offen sc1
Y_END:
    s_endpgm
L_END:
    s_endpgm
.section .rodata,"a"
.p2align 6
.amdhsa_kernel sequential_preLN__compressed_kv_cla__glu_gated_glu__decode_kernel
  .amdhsa_next_free_vgpr 128
  .amdhsa_next_free_sgpr 102
  .amdhsa_accum_offset 128
  .amdhsa_group_segment_fixed_size 0
  .amdhsa_kernarg_size 104
  .amdhsa_user_sgpr_count 2
  .amdhsa_user_sgpr_kernarg_segment_ptr 1
  .amdhsa_system_sgpr_workgroup_id_x 1
.end_amdhsa_kernel
```
